```python
import torch

def _softmax(x, axis=-1):
    return torch.softmax(x, dim=axis)
def _gelu(x):
    return torch.nn.functional.gelu(x, approximate="tanh")
def _silu(x):
    return torch.nn.functional.silu(x)
def _sigmoid(x):
    return torch.sigmoid(x)
def _layernorm(x, axis=-1, eps=1e-5):
    m = x.mean(dim=axis, keepdim=True)
    v = x.var(dim=axis, keepdim=True, unbiased=False)
    return (x - m) / torch.sqrt(v + eps)
def _scatter_add(tgt, idx, src, axis=0):
    return tgt.clone().index_add_(axis, idx, src)
def _segment_sum(src, seg, n):
    out = torch.zeros((n,) + src.shape[1:], dtype=src.dtype)
    return out.index_add_(0, seg, src)
def _pad(x, pw):
    flat = tuple(v for pair in reversed(pw) for v in pair)
    return torch.nn.functional.pad(x, flat)

kernel_name = 'gated_mix__linear_attn_block__ssm_conv_s5__prompt'

def setup_inputs():

    _w = (lambda a: (lambda t: t.to(torch.bfloat16) if t.is_floating_point() else t)(torch.as_tensor(a)))
    def _A_setup():
        B, S, D = 1, 2048, 512
        return {
            "x": _w((lambda *s: torch.randn(*s, dtype=torch.bfloat16) * 0.05)(B, S, D)),
            "wqkv": _w((lambda *s: torch.randn(*s, dtype=torch.bfloat16) * 0.8)(D, 3 * D)),
            "wo": _w((lambda *s: torch.randn(*s, dtype=torch.bfloat16) * 0.05)(D, D)),
        }
    _A_in = _A_setup()

    def _B_setup():
        B, S, D = 1, 2048, 512
        P = D
        Lambda_re = -0.5 * (lambda _x: torch.exp(torch.as_tensor(_x)))((lambda *s: torch.randn(*s, dtype=torch.bfloat16) * 0.2)(P))
        Lambda_im = (lambda *s: torch.randn(*s, dtype=torch.bfloat16) * 0.8)(P) * 1.0
        B_re = (lambda *s: torch.randn(*s, dtype=torch.bfloat16) * 0.4)(P, D) * (D ** -0.5)
        B_im = (lambda *s: torch.randn(*s, dtype=torch.bfloat16) * 0.4)(P, D) * (D ** -0.5)
        C_re = (lambda *s: torch.randn(*s, dtype=torch.bfloat16) * 0.4)(D, P) * (P ** -0.5)
        C_im = (lambda *s: torch.randn(*s, dtype=torch.bfloat16) * 0.4)(D, P) * (P ** -0.5)
        log_dt = (lambda *s: torch.randn(*s, dtype=torch.bfloat16) * 0.2)(P) * 0.3 - 2.0
        Dskip = (lambda *s: torch.randn(*s, dtype=torch.bfloat16) * 0.05)(D)
        return {
            "x": _w((lambda *s: torch.randn(*s, dtype=torch.bfloat16) * 0.05)(B, S, D)),
            "Lambda_re": _w(Lambda_re),
            "Lambda_im": _w(Lambda_im),
            "B_re": _w(B_re),
            "B_im": _w(B_im),
            "C_re": _w(C_re),
            "C_im": _w(C_im),
            "log_dt": _w(log_dt),
            "Dskip": _w(Dskip),
        }
    _B_in = _B_setup()

    return {
        "A_x": _A_in["x"],
        "A_wqkv": _A_in["wqkv"],
        "A_wo": _A_in["wo"],
        "B_x": _B_in["x"],
        "B_Lambda_re": _B_in["Lambda_re"],
        "B_Lambda_im": _B_in["Lambda_im"],
        "B_B_re": _B_in["B_re"],
        "B_B_im": _B_in["B_im"],
        "B_C_re": _B_in["C_re"],
        "B_C_im": _B_in["C_im"],
        "B_log_dt": _B_in["log_dt"],
        "B_Dskip": _B_in["Dskip"],
        "gate_w": _w((lambda *s: torch.randn(*s, dtype=torch.bfloat16) * 0.05)(512) * 16.0),
    }

def reference(A_x, A_wqkv, A_wo, B_x, B_Lambda_re, B_Lambda_im, B_B_re, B_B_im, B_C_re, B_C_im, B_log_dt, B_Dskip, gate_w):
    def _A_ref(x, wqkv, wo):
        B, S, D = x.shape
        H = 32; Dh = D // H
        qkv = (lambda x, *d: x.permute(*d))((x @ wqkv).reshape(B, S, 3, H, Dh), 2, 0, 3, 1, 4)
        q, k, v = qkv[0], qkv[1], qkv[2]
        phi = lambda t: torch.where(t > 0, t + 1, torch.exp(t)) + 1e-6
        pq, pk = phi(q), phi(k)
        kv = torch.einsum("bhsd,bhse->bhde", pk, v)
        z = torch.einsum("bhsd->bhd", pk)
        num = torch.einsum("bhqd,bhde->bhqe", pq, kv)
        den = torch.einsum("bhqd,bhd->bhq", pq, z)[..., None] + 1e-6
        o = num / den
        return (lambda x, *d: x.permute(*d))(o, 0, 2, 1, 3).reshape(B, S, D) @ wo

    def _B_ref(x, Lambda_re, Lambda_im, B_re, B_im, C_re, C_im, log_dt, Dskip):
        Bsz, L, H = x.shape
        Lam = Lambda_re + 1j * Lambda_im
        Bmat = B_re + 1j * B_im
        Cmat = C_re + 1j * C_im
        dt = torch.exp(log_dt)
        Lam_bar = torch.exp(dt * Lam)
        B_bar = ((Lam_bar - 1.0) / Lam)[:, None] * Bmat
        Bu = torch.einsum("bld,pd->blp", x + 0j, B_bar)
        h = torch.zeros_like(Bu[:, 0, :])
        hs = []
        for t in range(L):
            h = Lam_bar[None, :] * h + Bu[:, t, :]
            hs.append(h)
        hseq = torch.stack(hs, 1)
        y = 2.0 * torch.einsum("blp,dp->bld", hseq, Cmat).real + x * Dskip[None, None, :]
        return y

    x = A_x
    g = _sigmoid((x * gate_w).sum(-1, keepdims=True))
    a = _A_ref(x, A_wqkv, A_wo)
    b = _B_ref(x, B_Lambda_re, B_Lambda_im, B_B_re, B_B_im, B_C_re, B_C_im, B_log_dt, B_Dskip)
    return g * a + (1 - g) * b
```

```asm
; @launch grid=(256,1,1) block=(256,1,1) lds=163840
.amdgcn_target "amdgcn-amd-amdhsa--gfx950"
.text
.p2align 12
.fill 832, 4, 0xbf810000
.globl gated_mix__linear_attn_block__ssm_conv_s5__prompt_kernel
.p2align 8
.type gated_mix__linear_attn_block__ssm_conv_s5__prompt_kernel,@function
gated_mix__linear_attn_block__ssm_conv_s5__prompt_kernel:
    s_cmp_ge_u32 s2, 256
    s_cbranch_scc1 L_end
    s_load_dwordx16 s[4:19], s[0:1], 0
    s_load_dwordx16 s[20:35], s[0:1], 64
    s_getpc_b64 s[96:97]
L_pc:
    s_and_b32 s80, s2, 0xf8
    v_lshrrev_b32 v255, 5, v0
    v_add_lshl_u32 v255, s80, v255, 7
    v_min_u32 v255, L_end-L_pc, v255
    v_lshrrev_b32 v254, 6, v0
    global_load_dword v253, v255, s[96:97]
    v_readfirstlane_b32 s92, v254
    s_and_b32 s90, s2, 1
    s_bfe_u32 s80, s2, 0x20001
    s_lshr_b32 s79, s2, 6
    s_lshl2_add_u32 s95, s80, s79
    s_bfe_u32 s80, s2, 0x20003
    s_lshl2_add_u32 s94, s90, s80
    s_bfe_u32 s93, s2, 0x10005
    s_lshl3_add_u32 s80, s93, s94
    s_lshl2_add_u32 s82, s80, s92
    s_cmp_eq_u32 s80, 11
    s_cselect_b32 s79, s79, 0
    s_lshl1_add_u32 s88, s79, s2
    s_and_b32 s88, s88, 6
    v_and_b32 v252, 63, v0
    v_lshlrev_b32 v252, 4, v252
    s_and_b32 s80, s82, 0x3e
    s_add_u32 s80, s80, s82
    s_lshl_b32 s79, s95, 7
    s_add_u32 s80, s80, s79
    v_lshl_add_u32 v249, s80, 10, v252
    s_mul_i32 s42, s93, 0x100000
    s_add_u32 s42, s42, 0x80000
    s_mov_b32 s46, s42
    s_mul_i32 s83, s93, 196480
    s_add_u32 s83, s83, 128
    s_mul_i32 s78, s93, 98304
    s_lshl_b32 s77, s93, 13
    s_add_u32 s77, s77, 2048
    s_mov_b32 s38, 0x200000
    s_mov_b32 s39, 0x20000
    s_mov_b32 s43, 0x20000
    s_mov_b32 s47, 0x20000
    s_mul_i32 s89, s92, 0x1400
    s_and_b32 s89, s89, 0x2400
    v_lshrrev_b32 v255, 4, v0
    v_xor_b32 v255, v0, v255
    v_bfe_u32 v248, v255, 0, 3
    v_lshlrev_b32 v248, 4, v248
    v_lshrrev_b32 v255, 3, v0
    v_and_b32 v255, 6, v255
    v_xor_b32 v255, v0, v255
    v_bfe_u32 v247, v255, 0, 3
    v_lshlrev_b32 v247, 4, v247
    v_bfe_u32 v255, v0, 3, 2
    v_bfe_u32 v254, v0, 5, 2
    v_lshl_or_b32 v255, v254, 3, v255
    v_lshrrev_b32 v254, 7, v0
    v_lshl_or_b32 v244, v254, 5, v255
    v_lshl_add_u32 v244, s94, 6, v244
    v_lshl_add_u32 v244, v244, 10, v248
    v_mul_u32_u24 v255, 3072, v255
    v_lshl_add_u32 v255, v254, 10, v255
    s_lshl_b32 s80, s94, 7
    s_add_u32 s80, s80, 1024
    s_cmp_eq_u32 s93, 0
    s_cselect_b64 vcc, -1, 0
    v_add3_u32 v255, v255, s80, v247
    v_cndmask_b32 v244, v255, v244, vcc
    v_add_u32 v243, s77, v244
    v_add_u32 v242, s78, v244
    v_add_u32 v241, s78, v243
    v_and_b32 v246, 0x8, v0
    v_bfe_u32 v254, v0, 4, 1
    v_lshl_or_b32 v246, v254, 0, v246
    v_bfe_u32 v254, v0, 5, 3
    v_lshl_or_b32 v246, v254, 4, v246
    v_lshl_add_u32 v246, s95, 7, v246
    v_lshl_add_u32 v246, v246, 10, v248
    v_add_u32 v245, 4096, v246
    s_mov_b32 s81, s88
    s_waitcnt lgkmcnt(0)
    s_cselect_b64 s[40:41], s[16:17], s[6:7]
    s_cselect_b64 s[44:45], s[18:19], s[6:7]
    s_mov_b64 s[36:37], s[4:5]
    global_load_dwordx4 v[8:11], v249, s[4:5]
    global_load_dwordx4 v[12:15], v249, s[4:5] offset:2048
    s_bfe_u32 s91, s2, 0x30003
    s_bfe_u32 s80, s2, 0x10006
    s_lshl_b32 s80, s80, 2
    s_xor_b32 s91, s91, s80
    v_and_b32 v251, 0x40, v0
    v_bfe_u32 v254, v0, 0, 2
    v_lshl_or_b32 v251, v254, 1, v251
    v_bfe_u32 v254, v0, 2, 2
    v_lshl_or_b32 v251, v254, 4, v251
    v_lshl_add_u32 v251, s94, 7, v251
    v_bfe_u32 v250, v0, 4, 2
    v_lshlrev_b32 v250, 3, v250
    v_bfe_u32 v254, v0, 7, 1
    v_lshl_or_b32 v250, v254, 6, v250
    v_lshl_add_u32 v250, s91, 7, v250
    global_load_dwordx4 v[16:19], v252, s[28:29]
    global_load_dwordx2 v[2:3], v250, s[26:27] offset:0
    global_load_dwordx2 v[4:5], v250, s[26:27] offset:32
    s_cmp_eq_u32 s93, 0
    s_cbranch_scc0 L_nopar
    global_load_ushort v238, v251, s[12:13] offset:0
    global_load_ushort v239, v251, s[12:13] offset:8
    global_load_ushort v236, v251, s[14:15] offset:0
    global_load_ushort v237, v251, s[14:15] offset:8
    global_load_ushort v234, v251, s[24:25] offset:0
    global_load_ushort v235, v251, s[24:25] offset:8
L_nopar:
    s_add_u32 m0, s89, 81920
    s_mul_i32 s86, s88, s83
    buffer_load_dwordx4 v244, s[40:43], s86 offen lds
    buffer_load_dwordx4 v243, s[40:43], s86 offen offset:2048 lds
    s_add_u32 m0, s89, 86016
    s_lshl_b32 s87, s88, 7
    buffer_load_dwordx4 v242, s[44:47], s86 offen lds
    buffer_load_dwordx4 v241, s[44:47], s86 offen offset:2048 lds
    s_add_u32 m0, s89, 65536
    s_add_u32 s88, s88, 1
    buffer_load_dwordx4 v246, s[36:39], s87 offen lds
    buffer_load_dwordx4 v246, s[36:39], s87 offen offset:2048 lds
    s_add_u32 m0, s89, 69632
    s_and_b32 s88, s88, 7
    buffer_load_dwordx4 v245, s[36:39], s87 offen lds
    buffer_load_dwordx4 v245, s[36:39], s87 offen offset:2048 lds
    s_load_dword s84, s[34:35], 0
    s_sub_u32 s81, s91, s81
    s_and_b32 s81, s81, 7
    s_mov_b64 s[48:49], s[34:35]
    s_mov_b32 s50, 0x10000000
    s_mov_b64 s[52:53], s[20:21]
    s_mov_b32 s54, 0x80000
    s_mov_b64 s[56:57], s[22:23]
    s_mov_b32 s58, 0x80000
    s_mov_b64 s[60:61], s[8:9]
    s_mov_b32 s62, 0x80000
    s_mov_b64 s[64:65], s[30:31]
    s_mov_b32 s66, 0x400000
    s_mov_b32 s70, 4096
    s_mov_b32 s51, 0x20000
    s_mov_b32 s55, 0x20000
    s_mov_b32 s59, 0x20000
    s_mov_b32 s63, 0x20000
    s_mov_b32 s67, 0x20000
    s_mov_b32 s71, 0x20000
    s_mov_b32 s72, 400000
    s_lshr_b32 s77, s92, 1
    s_and_b32 s78, s92, 1
    s_lshl1_add_u32 s73, s95, s77
    s_lshl1_add_u32 s79, s95, s90
    s_lshl1_add_u32 s74, s79, s78
    v_bfe_u32 v255, v0, 1, 3
    v_bfe_u32 v254, v0, 4, 2
    v_xor_b32 v233, v255, v254
    v_bfe_u32 v254, v0, 5, 1
    v_xor_b32 v209, v255, v254
    v_bfe_u32 v254, v0, 0, 4
    v_lshlrev_b32 v254, 7, v254
    v_lshl_add_u32 v233, v233, 4, v254
    v_lshl_add_u32 v209, v209, 4, v254
    v_bfe_u32 v254, v0, 4, 1
    v_lshl_or_b32 v209, v254, 3, v209
    s_and_b32 s80, s74, 3
    s_lshl_b32 s80, s80, 6
    s_add_u32 s80, s80, s77
    s_lshl_b32 s80, s80, 6
    v_xor_b32 v209, s80, v209
    v_xor_b32 v208, 32, v209
    v_add_u32 v207, 0x10000, v209
    v_add_u32 v206, 0x10000, v208
    v_bfe_u32 v224, v0, 2, 4
    v_lshlrev_b32 v224, 7, v224
    v_bfe_u32 v254, v0, 0, 2
    v_lshl_or_b32 v224, v254, 3, v224
    v_bfe_u32 v254, v0, 3, 2
    v_lshl_or_b32 v224, v254, 5, v224
    s_mul_i32 s80, s77, 16448
    s_add_u32 s80, s80, 131072
    v_xor_b32 v217, s80, v224
    v_xor_b32 v216, 32, v217
    v_xor_b32 v215, 64, v217
    v_xor_b32 v214, 96, v217
    s_lshl_b32 s76, s92, 13
    s_lshl_b32 s27, s2, 10
    s_add_u32 s26, s76, 131072
    s_lshr_b32 s80, s2, 7
    s_andn2_b32 s32, s80, s93
    s_lshl_b32 s33, s32, 9
    s_lshl_b32 s32, s32, 17
    v_bfe_u32 v254, v0, 3, 3
    v_bfe_u32 v255, v0, 6, 1
    v_lshl_or_b32 v254, v255, 6, v254
    v_bfe_u32 v255, v0, 7, 1
    v_lshl_or_b32 v254, v255, 8, v254
    v_lshl_add_u32 v254, v254, 10, v247
    v_lshl_add_u32 v223, s91, 7, v254
    v_add_u32 v222, 7168, v223
    v_add_u32 v221, 14336, v223
    v_add_u32 v220, 21504, v223
    s_lshl2_add_u32 s75, s77, s78
    s_lshl_b32 s75, s75, 10
    s_lshl_b32 s80, s33, 6
    s_add_u32 s75, s75, s80
    v_bfe_u32 v255, v0, 3, 4
    v_bfe_u32 v254, v0, 7, 1
    v_lshl_or_b32 v255, v254, 5, v255
    v_lshl_add_u32 v255, s91, 6, v255
    v_lshl_add_u32 v219, v255, 10, v248
    v_add_u32 v218, 14336, v219
    v_bfe_u32 v254, v0, 0, 4
    v_lshlrev_b32 v254, 4, v254
    v_add_u32 v254, 4096, v254
    v_lshl_add_u32 v231, s73, 9, v254
    v_lshl_add_u32 v230, s74, 8, v254
    v_and_b32 v255, 56, v0
    v_cmp_eq_u32 vcc, 24, v255
    v_add_u32 v255, 8388224, v252
    s_nop 0
    v_cndmask_b32 v225, v252, v255, vcc
    s_lshr_b32 s80, s2, 6
    s_and_b32 s79, s94, 3
    s_lshl2_add_u32 s80, s80, s79
    v_bfe_u32 v205, v0, 2, 3
    v_bfe_u32 v254, v0, 6, 2
    v_lshl_or_b32 v205, v254, 3, v205
    v_lshl_add_u32 v205, s80, 5, v205
    v_mul_u32_u24 v205, 24, v205
    v_and_or_b32 v205, v0, 3, v205
    v_lshl_add_u32 v205, s90, 2, v205
    v_lshlrev_b32 v205, 7, v205
    s_lshl4_add_u32 s80, s95, s94
    s_lshl_b32 s80, s80, 8
    s_add_u32 s80, s80, 65536
    v_bfe_u32 v226, v0, 6, 1
    v_lshlrev_b32 v226, 7, v226
    v_bfe_u32 v254, v0, 7, 1
    v_lshl_or_b32 v226, v254, 11, v226
    v_add_u32 v226, s80, v226
    v_lshl_add_u32 v226, s93, 16, v226
    v_bfe_u32 v232, v0, 0, 5
    v_lshlrev_b32 v232, 2, v232
    v_add_u32 v232, v232, v226
    s_cmp_eq_u32 s93, 0
    s_cbranch_scc0 L_att
    v_lshl_add_u32 v251, s77, 13, v233
    v_xor_b32 v250, 64, v251
    v_add_u32 v248, 0x10000, v251
    v_add_u32 v247, 0x10000, v250
    v_lshl_add_u32 v224, s78, 13, v233
    v_xor_b32 v204, 64, v224
    v_add_u32 v203, 0x10000, v224
    v_add_u32 v202, 0x10000, v204
    s_mov_b32 s22, 0xffff0000
    s_mov_b32 s23, 0xffff0000
    s_mov_b32 s20, 0
    s_mov_b32 s21, -1
    s_sub_u32 s18, 0, s77
    s_mov_b32 s19, s18
    v_lshrrev_b32 v255, 2, v0
    v_xor_b32 v255, v0, v255
    v_and_b32 v255, 12, v255
    v_and_or_b32 v255, v0, 2, v255
    v_cmp_eq_u32 vcc, 0, v255
    v_cmp_eq_u32 s[96:97], 2, v255
    v_bfe_i32 v254, v0, 0, 1
    v_xor_b32 v254, 0xffff, v254
    v_cndmask_b32 v200, 0, v254, vcc
    v_cndmask_b32 v201, 0, v254, s[96:97]
    s_lshl1_add_u32 s80, s94, s78
    s_lshl_b32 s80, s80, 12
    s_add_u32 s80, s80, 196608
    s_add_u32 s68, s48, s80
    s_addc_u32 s69, s49, 0
    v_bfe_u32 v255, v0, 0, 4
    v_lshlrev_b32 v255, 4, v255
    v_lshl_add_u32 v199, s95, 8, v255
    v_lshl_add_u32 v198, s92, 8, v255
    v_lshl_add_u32 v198, s33, 6, v198
    v_xor_b32 v198, 98304, v198
    v_bfe_u32 v197, v0, 4, 2
    v_lshlrev_b32 v197, 8, v197
    v_sub_u32 v197, v199, v197
    v_subrev_u32 v197, 256, v197
    v_and_b32 v255, 0xb0, v0
    v_cmp_eq_u32 vcc, 0x80, v255
    v_add_u32 v254, s80, v199
    v_mov_b32 v255, 0x20000000
    v_subrev_u32 v196, 1024, v197
    v_subrev_u32 v195, 2048, v197
    v_subrev_u32 v194, 3072, v197
    v_ashrrev_i32 v193, 31, v197
    v_ashrrev_i32 v192, 31, v196
    v_ashrrev_i32 v191, 31, v195
    v_ashrrev_i32 v190, 31, v194
    v_cndmask_b32 v199, v255, v199, vcc
    v_cndmask_b32 v226, v226, v254, vcc
    s_mul_i32 s80, s73, 196608
    s_and_b32 s79, s94, 4
    s_add_u32 s79, s79, s94
    s_lshl1_add_u32 s79, s79, s78
    s_lshl_b32 s79, s79, 11
    s_add_u32 s80, s80, s79
    s_add_u32 s17, s80, 1048576
    s_add_u32 s16, s80, 1064960
    s_add_u32 s15, s80, 1146880
    s_add_u32 s14, s80, 1163264
    global_load_dword v253, v226, s[48:49]
    s_add_u32 m0, s89, 114688
    s_mul_i32 s86, s88, s83
    buffer_load_dwordx4 v244, s[40:43], s86 offen lds
    buffer_load_dwordx4 v243, s[40:43], s86 offen offset:2048 lds
    s_add_u32 m0, s89, 118784
    s_lshl_b32 s87, s88, 7
    buffer_load_dwordx4 v242, s[44:47], s86 offen lds
    buffer_load_dwordx4 v241, s[44:47], s86 offen offset:2048 lds
    s_mov_b64 exec, 0
    s_cmp_eq_u32 s92, 0
    s_cbranch_scc1 L_pg683
    s_cmp_eq_u32 s92, 1
    s_cbranch_scc1 L_pg1264
    s_cmp_eq_u32 s92, 2
    s_cbranch_scc1 L_pg1825
    s_branch L_pg4144
L_backx:
    s_cmp_eq_u32 s93, 0
    s_cbranch_scc0 L_backa
L_backs:
    s_mov_b64 exec, -1
    s_add_u32 m0, s89, 98304
    s_add_u32 s88, s88, 1
    buffer_load_dwordx4 v246, s[36:39], s87 offen lds
    buffer_load_dwordx4 v246, s[36:39], s87 offen offset:2048 lds
    s_add_u32 m0, s89, 102400
    s_and_b32 s88, s88, 7
    buffer_load_dwordx4 v245, s[36:39], s87 offen lds
    buffer_load_dwordx4 v245, s[36:39], s87 offen offset:2048 lds
    s_branch L_loops
L_xd_s0:
    ds_read_b64 v[28:29], v207 offset:0
    ds_read_b64 v[30:31], v206 offset:0
    ds_read_b64 v[32:33], v207 offset:2048
    ds_read_b64 v[34:35], v206 offset:2048
    s_branch L_nx_s0
L_xd_s1:
    ds_read_b64 v[28:29], v207 offset:32768
    ds_read_b64 v[30:31], v206 offset:32768
    ds_read_b64 v[32:33], v207 offset:34816
    ds_read_b64 v[34:35], v206 offset:34816
    s_branch L_nx_s1
L_xd_s2:
    ds_read_b64 v[28:29], v209 offset:0
    ds_read_b64 v[30:31], v208 offset:0
    ds_read_b64 v[32:33], v209 offset:2048
    ds_read_b64 v[34:35], v208 offset:2048
    s_branch L_nx_s2
L_xd_s3:
    ds_read_b64 v[28:29], v209 offset:32768
    ds_read_b64 v[30:31], v208 offset:32768
    ds_read_b64 v[32:33], v209 offset:34816
    ds_read_b64 v[34:35], v208 offset:34816
    s_branch L_nx_s3
L_xd_s4:
    ds_read_b64 v[28:29], v207 offset:0
    ds_read_b64 v[30:31], v206 offset:0
    ds_read_b64 v[32:33], v207 offset:2048
    ds_read_b64 v[34:35], v206 offset:2048
    s_branch L_nx_s4
L_xd_s5:
    ds_read_b64 v[28:29], v207 offset:32768
    ds_read_b64 v[30:31], v206 offset:32768
    ds_read_b64 v[32:33], v207 offset:34816
    ds_read_b64 v[34:35], v206 offset:34816
    s_branch L_nx_s5
L_xd_s6:
    ds_read_b64 v[28:29], v209 offset:0
    ds_read_b64 v[30:31], v208 offset:0
    ds_read_b64 v[32:33], v209 offset:2048
    ds_read_b64 v[34:35], v208 offset:2048
    s_branch L_nx_s6
L_xd_s7:
    ds_read_b64 v[28:29], v209 offset:32768
    ds_read_b64 v[30:31], v208 offset:32768
    ds_read_b64 v[32:33], v209 offset:34816
    ds_read_b64 v[34:35], v208 offset:34816
    s_branch L_nx_s7
L_loops:
    s_waitcnt vmcnt(9) lgkmcnt(0)
    s_barrier
    ds_read_b128 a[80:83], v203 offset:16384
    ds_read_b128 a[64:67], v248 offset:0
    ds_read_b128 a[68:71], v248 offset:2048
    ds_read_b128 a[72:75], v248 offset:4096
    ds_read_b128 a[76:79], v248 offset:6144
    ds_read_b128 a[84:87], v203 offset:20480
    s_add_u32 s84, s84, 1
    s_mul_i32 s85, s84, 0x9e3779b1
    v_mov_b32 v240, s85
    s_waitcnt lgkmcnt(3)
    v_mfma_f32_16x16x32_bf16 v[124:127], a[64:67], a[80:83], 0
    ds_read_b128 a[88:91], v203 offset:18432
    v_mov_b32 v20, 0
    v_mov_b32 v22, 0
    v_dot2c_f32_bf16 v20, v8, v16
    v_mfma_f32_16x16x32_bf16 v[128:131], a[68:71], a[80:83], 0
    v_dot2c_f32_bf16 v22, v12, v16
    v_dot2c_f32_bf16 v20, v9, v17
    v_dot2c_f32_bf16 v22, v13, v17
    s_waitcnt lgkmcnt(2)
    v_mfma_f32_16x16x32_bf16 v[132:135], a[72:75], a[80:83], 0
    v_dot2c_f32_bf16 v20, v10, v18
    v_dot2c_f32_bf16 v22, v14, v18
    v_dot2c_f32_bf16 v20, v11, v19
    v_mfma_f32_16x16x32_bf16 v[136:139], a[76:79], a[80:83], 0
    s_cmp_eq_u32 s81, 0
    s_cbranch_scc1 L_xd_s0
L_nx_s0:
    v_dot2c_f32_bf16 v22, v15, v19
    v_mov_b32 v21, v240
    v_mov_b32 v23, v240
    s_waitcnt lgkmcnt(1)
    v_mfma_f32_16x16x32_bf16 v[156:159], a[64:67], a[84:87], 0
    ds_read_b128 a[92:95], v203 offset:22528
    s_add_u32 m0, s89, 16384
    v_cmp_eq_u32 vcc, 0x3f0, v252
    v_add_f32_dpp v20, v20, v20 row_shr:1 row_mask:0xf bank_mask:0xf
    v_add_f32_dpp v22, v22, v22 row_shr:1 row_mask:0xf bank_mask:0xf
    v_mfma_f32_16x16x32_bf16 v[160:163], a[68:71], a[84:87], 0
    s_mul_i32 s86, s88, s83
    v_mov_b32 v189, 0x20000000
    s_and_b32 s13, s82, 32
    v_add_f32_dpp v20, v20, v20 row_shr:2 row_mask:0xf bank_mask:0xf
    v_mfma_f32_16x16x32_bf16 v[164:167], a[72:75], a[84:87], 0
    buffer_load_dwordx4 v244, s[40:43], s86 offen lds
    v_add_f32_dpp v22, v22, v22 row_shr:2 row_mask:0xf bank_mask:0xf
    s_bfe_u32 s12, s82, 0x10001
    v_mfma_f32_16x16x32_bf16 v[168:171], a[76:79], a[84:87], 0
    s_lshl4_add_u32 s13, s12, s13
    v_add_f32_dpp v20, v20, v20 row_shr:4 row_mask:0xf bank_mask:0xf
    s_waitcnt lgkmcnt(1)
    v_mfma_f32_16x16x32_bf16 v[140:143], a[64:67], a[88:91], 0
    ds_read_b128 a[112:115], v202 offset:16384
    buffer_load_dwordx4 v243, s[40:43], s86 offen offset:2048 lds
    s_add_u32 m0, s89, 20480
    v_add_f32_dpp v22, v22, v22 row_shr:4 row_mask:0xf bank_mask:0xf
    s_bfe_u32 s12, s82, 0x20003
    v_mfma_f32_16x16x32_bf16 v[144:147], a[68:71], a[88:91], 0
    ds_read_b128 a[96:99], v247 offset:0
    s_lshl_b32 s87, s88, 7
    s_lshl2_add_u32 s13, s12, s13
    v_add_f32_dpp v20, v20, v20 row_shr:8 row_mask:0xf bank_mask:0xf
    v_mfma_f32_16x16x32_bf16 v[148:151], a[72:75], a[88:91], 0
    ds_read_b128 a[100:103], v247 offset:2048
    buffer_load_dwordx4 v242, s[44:47], s86 offen lds
    v_add_f32_dpp v22, v22, v22 row_shr:8 row_mask:0xf bank_mask:0xf
    s_bfe_u32 s12, s82, 0x10000
    v_mfma_f32_16x16x32_bf16 v[152:155], a[76:79], a[88:91], 0
    ds_read_b128 a[104:107], v247 offset:4096
    s_lshl1_add_u32 s13, s12, s13
    v_add_f32_dpp v20, v20, v20 row_bcast:15 row_mask:0xa bank_mask:0xf
    s_waitcnt lgkmcnt(4)
    v_mfma_f32_16x16x32_bf16 v[172:175], a[64:67], a[92:95], 0
    ds_read_b128 a[108:111], v247 offset:6144
    buffer_load_dwordx4 v241, s[44:47], s86 offen offset:2048 lds
    s_add_u32 m0, s89, 0
    v_add_f32_dpp v22, v22, v22 row_bcast:15 row_mask:0xa bank_mask:0xf
    s_bfe_u32 s12, s82, 0x10002
    v_mfma_f32_16x16x32_bf16 v[176:179], a[68:71], a[92:95], 0
    ds_read_b128 a[116:119], v202 offset:20480
    s_add_u32 s88, s88, 1
    s_add_u32 s13, s12, s13
    v_add_f32_dpp v20, v20, v20 row_bcast:31 row_mask:0xc bank_mask:0xf
    v_mfma_f32_16x16x32_bf16 v[180:183], a[72:75], a[92:95], 0
    buffer_load_dwordx4 v246, s[36:39], s87 offen lds
    v_add_f32_dpp v22, v22, v22 row_bcast:31 row_mask:0xc bank_mask:0xf
    v_cndmask_b32 v189, v189, 0, vcc
    v_mfma_f32_16x16x32_bf16 v[184:187], a[76:79], a[92:95], 0
    s_lshl_b32 s12, s95, 10
    v_mul_f32 v20, 0xbfb8aa3b, v20
    s_waitcnt lgkmcnt(3)
    v_mfma_f32_16x16x32_bf16 v[124:127], a[96:99], a[112:115], v[124:127]
    ds_read_b128 a[120:123], v202 offset:18432
    buffer_load_dwordx4 v246, s[36:39], s87 offen offset:2048 lds
    s_add_u32 m0, s89, 4096
    v_mul_f32 v22, 0xbfb8aa3b, v22
    v_exp_f32 v20, v20
    v_mfma_f32_16x16x32_bf16 v[128:131], a[100:103], a[112:115], v[128:131]
    s_and_b32 s88, s88, 7
    v_exp_f32 v22, v22
    v_add_f32 v20, 1.0, v20
    s_waitcnt lgkmcnt(2)
    v_mfma_f32_16x16x32_bf16 v[132:135], a[104:107], a[112:115], v[132:135]
    buffer_load_dwordx4 v245, s[36:39], s87 offen lds
    v_add_f32 v22, 1.0, v22
    v_rcp_f32 v20, v20
    v_mfma_f32_16x16x32_bf16 v[136:139], a[108:111], a[112:115], v[136:139]
    v_rcp_f32 v22, v22
    s_lshl4_add_u32 s13, s13, s12
    s_waitcnt lgkmcnt(1)
    v_mfma_f32_16x16x32_bf16 v[156:159], a[96:99], a[116:119], v[156:159]
    ds_read_b128 a[124:127], v202 offset:22528
    buffer_load_dwordx4 v245, s[36:39], s87 offen offset:2048 lds
    s_add_u32 s13, s13, 4096
    v_cvt_pk_bf16_f32 v20, 0, v20
    v_mfma_f32_16x16x32_bf16 v[160:163], a[100:103], a[116:119], v[160:163]
    v_cvt_pk_bf16_f32 v22, 0, v22
    buffer_store_dwordx4 v[20:23], v189, s[48:51], s13 offen sc1
    v_mfma_f32_16x16x32_bf16 v[164:167], a[104:107], a[116:119], v[164:167]
    v_mfma_f32_16x16x32_bf16 v[168:171], a[108:111], a[116:119], v[168:171]
    s_waitcnt vmcnt(9)
    s_barrier
    s_waitcnt lgkmcnt(1)
    v_mfma_f32_16x16x32_bf16 v[140:143], a[96:99], a[120:123], v[140:143]
    ds_read_b128 a[80:83], v203 offset:49152
    s_add_u32 m0, s89, 49152
    v_mfma_f32_16x16x32_bf16 v[144:147], a[100:103], a[120:123], v[144:147]
    ds_read_b128 a[64:67], v248 offset:32768
    s_mul_i32 s86, s88, s83
    v_mfma_f32_16x16x32_bf16 v[148:151], a[104:107], a[120:123], v[148:151]
    ds_read_b128 a[68:71], v248 offset:34816
    buffer_load_dwordx4 v244, s[40:43], s86 offen lds
    v_mfma_f32_16x16x32_bf16 v[152:155], a[108:111], a[120:123], v[152:155]
    ds_read_b128 a[72:75], v248 offset:36864
    s_waitcnt lgkmcnt(4)
    v_mfma_f32_16x16x32_bf16 v[172:175], a[96:99], a[124:127], v[172:175]
    ds_read_b128 a[76:79], v248 offset:38912
    v_mfma_f32_16x16x32_bf16 v[176:179], a[100:103], a[124:127], v[176:179]
    ds_read_b128 a[84:87], v203 offset:53248
    v_mfma_f32_16x16x32_bf16 v[180:183], a[104:107], a[124:127], v[180:183]
    buffer_load_dwordx4 v243, s[40:43], s86 offen offset:2048 lds
    v_mfma_f32_16x16x32_bf16 v[184:187], a[108:111], a[124:127], v[184:187]
    s_waitcnt lgkmcnt(3)
    v_mfma_f32_16x16x32_bf16 v[124:127], a[64:67], a[80:83], v[124:127]
    ds_read_b128 a[88:91], v203 offset:51200
    s_add_u32 m0, s89, 53248
    v_mfma_f32_16x16x32_bf16 v[128:131], a[68:71], a[80:83], v[128:131]
    s_lshl_b32 s87, s88, 7
    s_waitcnt lgkmcnt(2)
    v_mfma_f32_16x16x32_bf16 v[132:135], a[72:75], a[80:83], v[132:135]
    buffer_load_dwordx4 v242, s[44:47], s86 offen lds
    v_mfma_f32_16x16x32_bf16 v[136:139], a[76:79], a[80:83], v[136:139]
    s_cmp_eq_u32 s81, 1
    s_cbranch_scc1 L_xd_s1
L_nx_s1:
    s_waitcnt lgkmcnt(1)
    v_mfma_f32_16x16x32_bf16 v[156:159], a[64:67], a[84:87], v[156:159]
    ds_read_b128 a[92:95], v203 offset:55296
    v_mfma_f32_16x16x32_bf16 v[160:163], a[68:71], a[84:87], v[160:163]
    v_mfma_f32_16x16x32_bf16 v[164:167], a[72:75], a[84:87], v[164:167]
    buffer_load_dwordx4 v241, s[44:47], s86 offen offset:2048 lds
    v_mfma_f32_16x16x32_bf16 v[168:171], a[76:79], a[84:87], v[168:171]
    s_waitcnt lgkmcnt(1)
    v_mfma_f32_16x16x32_bf16 v[140:143], a[64:67], a[88:91], v[140:143]
    ds_read_b128 a[112:115], v202 offset:49152
    s_add_u32 m0, s89, 32768
    v_mfma_f32_16x16x32_bf16 v[144:147], a[68:71], a[88:91], v[144:147]
    ds_read_b128 a[96:99], v247 offset:32768
    s_add_u32 s88, s88, 1
    v_mfma_f32_16x16x32_bf16 v[148:151], a[72:75], a[88:91], v[148:151]
    ds_read_b128 a[100:103], v247 offset:34816
    buffer_load_dwordx4 v246, s[36:39], s87 offen lds
    v_mfma_f32_16x16x32_bf16 v[152:155], a[76:79], a[88:91], v[152:155]
    ds_read_b128 a[104:107], v247 offset:36864
    s_waitcnt lgkmcnt(4)
    v_mfma_f32_16x16x32_bf16 v[172:175], a[64:67], a[92:95], v[172:175]
    ds_read_b128 a[108:111], v247 offset:38912
    v_mfma_f32_16x16x32_bf16 v[176:179], a[68:71], a[92:95], v[176:179]
    ds_read_b128 a[116:119], v202 offset:53248
    v_mfma_f32_16x16x32_bf16 v[180:183], a[72:75], a[92:95], v[180:183]
    buffer_load_dwordx4 v246, s[36:39], s87 offen offset:2048 lds
    v_mfma_f32_16x16x32_bf16 v[184:187], a[76:79], a[92:95], v[184:187]
    s_waitcnt lgkmcnt(3)
    v_mfma_f32_16x16x32_bf16 v[124:127], a[96:99], a[112:115], v[124:127]
    ds_read_b128 a[120:123], v202 offset:51200
    s_add_u32 m0, s89, 36864
    v_mfma_f32_16x16x32_bf16 v[128:131], a[100:103], a[112:115], v[128:131]
    s_and_b32 s88, s88, 7
    s_waitcnt lgkmcnt(2)
    v_mfma_f32_16x16x32_bf16 v[132:135], a[104:107], a[112:115], v[132:135]
    buffer_load_dwordx4 v245, s[36:39], s87 offen lds
    v_mfma_f32_16x16x32_bf16 v[136:139], a[108:111], a[112:115], v[136:139]
    s_waitcnt lgkmcnt(1)
    v_mfma_f32_16x16x32_bf16 v[156:159], a[96:99], a[116:119], v[156:159]
    ds_read_b128 a[124:127], v202 offset:55296
    v_mfma_f32_16x16x32_bf16 v[160:163], a[100:103], a[116:119], v[160:163]
    v_mfma_f32_16x16x32_bf16 v[164:167], a[104:107], a[116:119], v[164:167]
    buffer_load_dwordx4 v245, s[36:39], s87 offen offset:2048 lds
    v_mfma_f32_16x16x32_bf16 v[168:171], a[108:111], a[116:119], v[168:171]
    s_waitcnt vmcnt(9)
    s_barrier
    s_waitcnt lgkmcnt(1)
    v_mfma_f32_16x16x32_bf16 v[140:143], a[96:99], a[120:123], v[140:143]
    ds_read_b128 a[80:83], v224 offset:16384
    s_add_u32 m0, s89, 81920
    v_mfma_f32_16x16x32_bf16 v[144:147], a[100:103], a[120:123], v[144:147]
    ds_read_b128 a[64:67], v251 offset:0
    s_mul_i32 s86, s88, s83
    v_mfma_f32_16x16x32_bf16 v[148:151], a[104:107], a[120:123], v[148:151]
    ds_read_b128 a[68:71], v251 offset:2048
    buffer_load_dwordx4 v244, s[40:43], s86 offen lds
    v_mfma_f32_16x16x32_bf16 v[152:155], a[108:111], a[120:123], v[152:155]
    ds_read_b128 a[72:75], v251 offset:4096
    s_waitcnt lgkmcnt(4)
    v_mfma_f32_16x16x32_bf16 v[172:175], a[96:99], a[124:127], v[172:175]
    ds_read_b128 a[76:79], v251 offset:6144
    v_mfma_f32_16x16x32_bf16 v[176:179], a[100:103], a[124:127], v[176:179]
    ds_read_b128 a[84:87], v224 offset:20480
    v_mfma_f32_16x16x32_bf16 v[180:183], a[104:107], a[124:127], v[180:183]
    buffer_load_dwordx4 v243, s[40:43], s86 offen offset:2048 lds
    v_mfma_f32_16x16x32_bf16 v[184:187], a[108:111], a[124:127], v[184:187]
    s_waitcnt lgkmcnt(3)
    v_mfma_f32_16x16x32_bf16 v[124:127], a[64:67], a[80:83], v[124:127]
    ds_read_b128 a[88:91], v224 offset:18432
    s_add_u32 m0, s89, 86016
    v_mfma_f32_16x16x32_bf16 v[128:131], a[68:71], a[80:83], v[128:131]
    s_lshl_b32 s87, s88, 7
    s_waitcnt lgkmcnt(2)
    v_mfma_f32_16x16x32_bf16 v[132:135], a[72:75], a[80:83], v[132:135]
    buffer_load_dwordx4 v242, s[44:47], s86 offen lds
    v_mfma_f32_16x16x32_bf16 v[136:139], a[76:79], a[80:83], v[136:139]
    s_cmp_eq_u32 s81, 2
    s_cbranch_scc1 L_xd_s2
L_nx_s2:
    s_waitcnt lgkmcnt(1)
    v_mfma_f32_16x16x32_bf16 v[156:159], a[64:67], a[84:87], v[156:159]
    ds_read_b128 a[92:95], v224 offset:22528
    v_mfma_f32_16x16x32_bf16 v[160:163], a[68:71], a[84:87], v[160:163]
    v_mfma_f32_16x16x32_bf16 v[164:167], a[72:75], a[84:87], v[164:167]
    buffer_load_dwordx4 v241, s[44:47], s86 offen offset:2048 lds
    v_mfma_f32_16x16x32_bf16 v[168:171], a[76:79], a[84:87], v[168:171]
    s_waitcnt lgkmcnt(1)
    v_mfma_f32_16x16x32_bf16 v[140:143], a[64:67], a[88:91], v[140:143]
    ds_read_b128 a[112:115], v204 offset:16384
    s_add_u32 m0, s89, 65536
    v_mfma_f32_16x16x32_bf16 v[144:147], a[68:71], a[88:91], v[144:147]
    ds_read_b128 a[96:99], v250 offset:0
    s_add_u32 s88, s88, 1
    v_mfma_f32_16x16x32_bf16 v[148:151], a[72:75], a[88:91], v[148:151]
    ds_read_b128 a[100:103], v250 offset:2048
    buffer_load_dwordx4 v246, s[36:39], s87 offen lds
L_pg683:
    s_cbranch_execz L_pg4212
    v_mfma_f32_16x16x32_bf16 v[152:155], a[76:79], a[88:91], v[152:155]
    ds_read_b128 a[104:107], v250 offset:4096
    s_waitcnt lgkmcnt(4)
    v_mfma_f32_16x16x32_bf16 v[172:175], a[64:67], a[92:95], v[172:175]
    ds_read_b128 a[108:111], v250 offset:6144
    v_mfma_f32_16x16x32_bf16 v[176:179], a[68:71], a[92:95], v[176:179]
    ds_read_b128 a[116:119], v204 offset:20480
    v_mfma_f32_16x16x32_bf16 v[180:183], a[72:75], a[92:95], v[180:183]
    buffer_load_dwordx4 v246, s[36:39], s87 offen offset:2048 lds
    v_mfma_f32_16x16x32_bf16 v[184:187], a[76:79], a[92:95], v[184:187]
    s_waitcnt lgkmcnt(3)
    v_mfma_f32_16x16x32_bf16 v[124:127], a[96:99], a[112:115], v[124:127]
    ds_read_b128 a[120:123], v204 offset:18432
    s_add_u32 m0, s89, 69632
    v_mfma_f32_16x16x32_bf16 v[128:131], a[100:103], a[112:115], v[128:131]
    s_and_b32 s88, s88, 7
    s_waitcnt lgkmcnt(2)
    v_mfma_f32_16x16x32_bf16 v[132:135], a[104:107], a[112:115], v[132:135]
    buffer_load_dwordx4 v245, s[36:39], s87 offen lds
    v_mfma_f32_16x16x32_bf16 v[136:139], a[108:111], a[112:115], v[136:139]
    s_waitcnt lgkmcnt(1)
    v_mfma_f32_16x16x32_bf16 v[156:159], a[96:99], a[116:119], v[156:159]
    ds_read_b128 a[124:127], v204 offset:22528
    v_mfma_f32_16x16x32_bf16 v[160:163], a[100:103], a[116:119], v[160:163]
    v_mfma_f32_16x16x32_bf16 v[164:167], a[104:107], a[116:119], v[164:167]
    buffer_load_dwordx4 v245, s[36:39], s87 offen offset:2048 lds
    v_mfma_f32_16x16x32_bf16 v[168:171], a[108:111], a[116:119], v[168:171]
    s_waitcnt vmcnt(8)
    s_barrier
    s_waitcnt lgkmcnt(1)
    v_mfma_f32_16x16x32_bf16 v[140:143], a[96:99], a[120:123], v[140:143]
    ds_read_b128 a[80:83], v224 offset:49152
    s_add_u32 m0, s89, 114688
    v_mfma_f32_16x16x32_bf16 v[144:147], a[100:103], a[120:123], v[144:147]
    ds_read_b128 a[64:67], v251 offset:32768
    s_mul_i32 s86, s88, s83
    v_mfma_f32_16x16x32_bf16 v[148:151], a[104:107], a[120:123], v[148:151]
    ds_read_b128 a[68:71], v251 offset:34816
    buffer_load_dwordx4 v244, s[40:43], s86 offen lds
    v_mfma_f32_16x16x32_bf16 v[152:155], a[108:111], a[120:123], v[152:155]
    ds_read_b128 a[72:75], v251 offset:36864
    s_waitcnt lgkmcnt(4)
    v_mfma_f32_16x16x32_bf16 v[172:175], a[96:99], a[124:127], v[172:175]
    ds_read_b128 a[76:79], v251 offset:38912
    v_mfma_f32_16x16x32_bf16 v[176:179], a[100:103], a[124:127], v[176:179]
    ds_read_b128 a[84:87], v224 offset:53248
    v_mfma_f32_16x16x32_bf16 v[180:183], a[104:107], a[124:127], v[180:183]
    buffer_load_dwordx4 v243, s[40:43], s86 offen offset:2048 lds
    v_mfma_f32_16x16x32_bf16 v[184:187], a[108:111], a[124:127], v[184:187]
    s_waitcnt lgkmcnt(3)
    v_mfma_f32_16x16x32_bf16 v[124:127], a[64:67], a[80:83], v[124:127]
    ds_read_b128 a[88:91], v224 offset:51200
    s_add_u32 m0, s89, 118784
    v_mfma_f32_16x16x32_bf16 v[128:131], a[68:71], a[80:83], v[128:131]
    s_lshl_b32 s87, s88, 7
    s_waitcnt lgkmcnt(2)
    v_mfma_f32_16x16x32_bf16 v[132:135], a[72:75], a[80:83], v[132:135]
    buffer_load_dwordx4 v242, s[44:47], s86 offen lds
    v_mfma_f32_16x16x32_bf16 v[136:139], a[76:79], a[80:83], v[136:139]
    s_cmp_eq_u32 s81, 3
    s_cbranch_scc1 L_xd_s3
L_nx_s3:
    s_waitcnt lgkmcnt(1)
    v_mfma_f32_16x16x32_bf16 v[156:159], a[64:67], a[84:87], v[156:159]
    ds_read_b128 a[92:95], v224 offset:55296
    v_lshlrev_b32 v238, 16, v238
    v_lshlrev_b32 v239, 16, v239
    v_lshlrev_b32 v236, 16, v236
    v_lshlrev_b32 v237, 16, v237
    v_lshlrev_b32 v234, 16, v234
    v_lshlrev_b32 v235, 16, v235
    v_mul_f32 v234, 0x3fb8aa3b, v234
    v_mul_f32 v235, 0x3fb8aa3b, v235
    v_exp_f32 v234, v234
    v_exp_f32 v235, v235
    v_pk_mul_f32 v[40:41], v[238:239], v[238:239]
    v_cvt_pk_bf16_f32 v234, 0, v234
    v_cvt_pk_bf16_f32 v235, 0, v235
    v_pk_fma_f32 v[40:41], v[236:237], v[236:237], v[40:41]
    v_pk_mul_f32 v[36:37], v[234:235], v[238:239]
    v_pk_mul_f32 v[38:39], v[234:235], v[236:237]
    v_mul_f32 v36, 0x3fb8aa3b, v36
    v_mul_f32 v37, 0x3fb8aa3b, v37
    v_mul_f32 v38, 0.15915494, v38
    v_mul_f32 v39, 0.15915494, v39
    v_exp_f32 v36, v36
    v_exp_f32 v37, v37
    v_rndne_f32 v42, v38
    v_rndne_f32 v43, v39
    v_sub_f32 v38, v38, v42
    v_sub_f32 v39, v39, v43
    v_rcp_f32 v40, v40
    v_rcp_f32 v41, v41
    v_cos_f32 v76, v38
    v_cos_f32 v77, v39
    v_sin_f32 v78, v38
    v_sin_f32 v79, v39
    v_mfma_f32_16x16x32_bf16 v[160:163], a[68:71], a[84:87], v[160:163]
    v_pk_add_f32 v[40:41], v[40:41], v[40:41]
    v_pk_mul_f32 v[76:77], v[76:77], v[36:37]
    v_pk_mul_f32 v[78:79], v[78:79], v[36:37]
    v_add_f32 v36, -1.0, v76
    v_add_f32 v37, -1.0, v77
    v_pk_mul_f32 v[80:81], v[36:37], v[238:239]
    v_pk_mul_f32 v[82:83], v[78:79], v[238:239]
    v_pk_fma_f32 v[80:81], v[78:79], v[236:237], v[80:81]
    v_pk_fma_f32 v[82:83], v[36:37], v[236:237], v[82:83] neg_lo:[1,0,0] neg_hi:[1,0,0]
    v_pk_mul_f32 v[80:81], v[80:81], v[40:41]
    v_pk_mul_f32 v[82:83], v[82:83], v[40:41]
    v_pk_mul_f32 v[36:37], v[76:77], v[76:77]
    v_pk_mul_f32 v[38:39], v[76:77], v[78:79]
    v_pk_fma_f32 v[36:37], v[78:79], v[78:79], v[36:37] neg_lo:[1,0,0] neg_hi:[1,0,0]
    v_pk_add_f32 v[38:39], v[38:39], v[38:39]
    v_pk_mul_f32 v[40:41], v[36:37], v[36:37]
    v_pk_mul_f32 v[42:43], v[36:37], v[38:39]
    v_pk_fma_f32 v[40:41], v[38:39], v[38:39], v[40:41] neg_lo:[1,0,0] neg_hi:[1,0,0]
    v_pk_add_f32 v[42:43], v[42:43], v[42:43]
    v_pk_mul_f32 v[84:85], v[40:41], v[40:41]
    v_pk_mul_f32 v[86:87], v[40:41], v[42:43]
    v_pk_fma_f32 v[84:85], v[42:43], v[42:43], v[84:85] neg_lo:[1,0,0] neg_hi:[1,0,0]
    v_pk_add_f32 v[86:87], v[86:87], v[86:87]
    v_pk_mul_f32 v[88:89], v[84:85], v[84:85]
    v_pk_mul_f32 v[90:91], v[84:85], v[86:87]
    v_pk_fma_f32 v[88:89], v[86:87], v[86:87], v[88:89] neg_lo:[1,0,0] neg_hi:[1,0,0]
    v_pk_add_f32 v[90:91], v[90:91], v[90:91]
    v_pk_mul_f32 v[92:93], v[88:89], v[88:89]
    v_pk_mul_f32 v[94:95], v[88:89], v[90:91]
    v_pk_fma_f32 v[92:93], v[90:91], v[90:91], v[92:93] neg_lo:[1,0,0] neg_hi:[1,0,0]
    v_pk_add_f32 v[94:95], v[94:95], v[94:95]
    v_pk_mul_f32 v[96:97], v[92:93], v[92:93]
    v_mfma_f32_16x16x32_bf16 v[164:167], a[72:75], a[84:87], v[164:167]
    buffer_load_dwordx4 v241, s[44:47], s86 offen offset:2048 lds
    v_pk_mul_f32 v[98:99], v[92:93], v[94:95]
    v_pk_fma_f32 v[96:97], v[94:95], v[94:95], v[96:97] neg_lo:[1,0,0] neg_hi:[1,0,0]
    v_pk_add_f32 v[98:99], v[98:99], v[98:99]
    v_pk_mul_f32 v[36:37], v[96:97], v[96:97]
    v_pk_mul_f32 v[38:39], v[96:97], v[98:99]
    v_pk_fma_f32 v[36:37], v[98:99], v[98:99], v[36:37] neg_lo:[1,0,0] neg_hi:[1,0,0]
    v_pk_add_f32 v[38:39], v[38:39], v[38:39]
    v_pk_mul_f32 v[40:41], v[36:37], v[36:37]
    v_pk_mul_f32 v[42:43], v[36:37], v[38:39]
    v_pk_fma_f32 v[40:41], v[38:39], v[38:39], v[40:41] neg_lo:[1,0,0] neg_hi:[1,0,0]
    v_pk_add_f32 v[42:43], v[42:43], v[42:43]
    v_pk_mul_f32 v[100:101], v[40:41], v[40:41]
    v_pk_mul_f32 v[102:103], v[40:41], v[42:43]
    v_pk_fma_f32 v[100:101], v[42:43], v[42:43], v[100:101] neg_lo:[1,0,0] neg_hi:[1,0,0]
    v_pk_add_f32 v[102:103], v[102:103], v[102:103]
    v_cndmask_b32 v36, 1.0, v36, s[22:23]
    v_cndmask_b32 v37, 1.0, v37, s[22:23]
    v_cndmask_b32 v38, 0, v38, s[22:23]
    v_cndmask_b32 v39, 0, v39, s[22:23]
    v_cndmask_b32 v40, 1.0, v40, s[20:21]
    v_cndmask_b32 v41, 1.0, v41, s[20:21]
    v_cndmask_b32 v42, 0, v42, s[20:21]
    v_cndmask_b32 v43, 0, v43, s[20:21]
    v_pk_mul_f32 v[104:105], v[36:37], v[40:41]
    v_pk_mul_f32 v[106:107], v[36:37], v[42:43]
    v_pk_fma_f32 v[104:105], v[38:39], v[42:43], v[104:105] neg_lo:[1,0,0] neg_hi:[1,0,0]
    v_pk_fma_f32 v[106:107], v[38:39], v[40:41], v[106:107]
    v_cndmask_b32 v108, 1.0, v88, s[22:23]
    v_cndmask_b32 v109, 1.0, v89, s[22:23]
    v_cndmask_b32 v110, 0, v90, s[22:23]
    v_cndmask_b32 v111, 0, v91, s[22:23]
    v_cndmask_b32 v112, 1.0, v92, s[20:21]
    v_mfma_f32_16x16x32_bf16 v[168:171], a[76:79], a[84:87], v[168:171]
    v_cndmask_b32 v113, 1.0, v93, s[20:21]
    v_cndmask_b32 v114, 0, v94, s[20:21]
    v_cndmask_b32 v115, 0, v95, s[20:21]
    v_cndmask_b32 v36, 1.0, v96, s[18:19]
    v_cndmask_b32 v37, 1.0, v97, s[18:19]
    v_cndmask_b32 v38, 0, v98, s[18:19]
    v_cndmask_b32 v39, 0, v99, s[18:19]
    v_pk_mul_f32 v[40:41], v[108:109], v[112:113]
    v_pk_mul_f32 v[42:43], v[108:109], v[114:115]
    v_pk_fma_f32 v[40:41], v[110:111], v[114:115], v[40:41] neg_lo:[1,0,0] neg_hi:[1,0,0]
    v_pk_fma_f32 v[42:43], v[110:111], v[112:113], v[42:43]
    v_pk_mul_f32 v[44:45], v[40:41], v[36:37]
    v_pk_mul_f32 v[46:47], v[40:41], v[38:39]
    v_pk_fma_f32 v[44:45], v[42:43], v[38:39], v[44:45] neg_lo:[1,0,0] neg_hi:[1,0,0]
    v_pk_fma_f32 v[46:47], v[42:43], v[36:37], v[46:47]
    v_mul_f32 v116, v80, v44
    v_mul_f32 v118, v80, v46
    v_fma_f32 v116, -v82, v46, v116
    v_fmac_f32 v118, v82, v44
    v_mul_f32 v117, v84, v116
    v_mul_f32 v119, v84, v118
    v_fma_f32 v117, -v86, v118, v117
    v_fmac_f32 v119, v86, v116
    v_mul_f32 v120, v81, v45
    v_mul_f32 v122, v81, v47
    v_fma_f32 v120, -v83, v47, v120
    v_fmac_f32 v122, v83, v45
    v_mul_f32 v121, v85, v120
    v_mul_f32 v123, v85, v122
    v_fma_f32 v121, -v87, v122, v121
    v_fmac_f32 v123, v87, v120
    s_waitcnt lgkmcnt(1)
    v_mfma_f32_16x16x32_bf16 v[140:143], a[64:67], a[88:91], v[140:143]
    ds_read_b128 a[112:115], v204 offset:49152
    s_add_u32 m0, s89, 98304
    v_mfma_f32_16x16x32_bf16 v[144:147], a[68:71], a[88:91], v[144:147]
    ds_read_b128 a[96:99], v250 offset:32768
    s_add_u32 s88, s88, 1
    v_mfma_f32_16x16x32_bf16 v[148:151], a[72:75], a[88:91], v[148:151]
    ds_read_b128 a[100:103], v250 offset:34816
    buffer_load_dwordx4 v246, s[36:39], s87 offen lds
    v_mfma_f32_16x16x32_bf16 v[152:155], a[76:79], a[88:91], v[152:155]
    ds_read_b128 a[104:107], v250 offset:36864
    s_waitcnt lgkmcnt(4)
    v_mfma_f32_16x16x32_bf16 v[172:175], a[64:67], a[92:95], v[172:175]
    ds_read_b128 a[108:111], v250 offset:38912
    v_mfma_f32_16x16x32_bf16 v[176:179], a[68:71], a[92:95], v[176:179]
    ds_read_b128 a[116:119], v204 offset:53248
    v_mfma_f32_16x16x32_bf16 v[180:183], a[72:75], a[92:95], v[180:183]
    buffer_load_dwordx4 v246, s[36:39], s87 offen offset:2048 lds
    v_mfma_f32_16x16x32_bf16 v[184:187], a[76:79], a[92:95], v[184:187]
    s_waitcnt lgkmcnt(3)
    v_mfma_f32_16x16x32_bf16 v[124:127], a[96:99], a[112:115], v[124:127]
    ds_read_b128 a[120:123], v204 offset:51200
    s_add_u32 m0, s89, 102400
    v_mfma_f32_16x16x32_bf16 v[128:131], a[100:103], a[112:115], v[128:131]
    s_and_b32 s88, s88, 7
    s_waitcnt lgkmcnt(2)
    v_mfma_f32_16x16x32_bf16 v[132:135], a[104:107], a[112:115], v[132:135]
    buffer_load_dwordx4 v245, s[36:39], s87 offen lds
    v_mfma_f32_16x16x32_bf16 v[136:139], a[108:111], a[112:115], v[136:139]
    s_waitcnt lgkmcnt(1)
    v_mfma_f32_16x16x32_bf16 v[156:159], a[96:99], a[116:119], v[156:159]
    ds_read_b128 a[124:127], v204 offset:55296
    v_mfma_f32_16x16x32_bf16 v[160:163], a[100:103], a[116:119], v[160:163]
    v_mfma_f32_16x16x32_bf16 v[164:167], a[104:107], a[116:119], v[164:167]
    buffer_load_dwordx4 v245, s[36:39], s87 offen offset:2048 lds
    v_mfma_f32_16x16x32_bf16 v[168:171], a[108:111], a[116:119], v[168:171]
    s_waitcnt vmcnt(8)
    s_barrier
    s_waitcnt lgkmcnt(1)
    v_mfma_f32_16x16x32_bf16 v[140:143], a[96:99], a[120:123], v[140:143]
    ds_read_b128 a[80:83], v203 offset:16384
    s_add_u32 m0, s89, 16384
    v_mfma_f32_16x16x32_bf16 v[144:147], a[100:103], a[120:123], v[144:147]
    ds_read_b128 a[64:67], v248 offset:0
    s_mul_i32 s86, s88, s83
    v_mfma_f32_16x16x32_bf16 v[148:151], a[104:107], a[120:123], v[148:151]
    ds_read_b128 a[68:71], v248 offset:2048
    buffer_load_dwordx4 v244, s[40:43], s86 offen lds
    v_mfma_f32_16x16x32_bf16 v[152:155], a[108:111], a[120:123], v[152:155]
    ds_read_b128 a[72:75], v248 offset:4096
    s_waitcnt lgkmcnt(4)
    v_mfma_f32_16x16x32_bf16 v[172:175], a[96:99], a[124:127], v[172:175]
    ds_read_b128 a[76:79], v248 offset:6144
    v_mfma_f32_16x16x32_bf16 v[176:179], a[100:103], a[124:127], v[176:179]
    ds_read_b128 a[84:87], v203 offset:20480
    v_mfma_f32_16x16x32_bf16 v[180:183], a[104:107], a[124:127], v[180:183]
    buffer_load_dwordx4 v243, s[40:43], s86 offen offset:2048 lds
    v_mfma_f32_16x16x32_bf16 v[184:187], a[108:111], a[124:127], v[184:187]
    s_waitcnt lgkmcnt(3)
    v_mfma_f32_16x16x32_bf16 v[124:127], a[64:67], a[80:83], v[124:127]
    ds_read_b128 a[88:91], v203 offset:18432
    s_add_u32 m0, s89, 20480
    v_mfma_f32_16x16x32_bf16 v[128:131], a[68:71], a[80:83], v[128:131]
    s_lshl_b32 s87, s88, 7
    s_waitcnt lgkmcnt(2)
    v_mfma_f32_16x16x32_bf16 v[132:135], a[72:75], a[80:83], v[132:135]
    buffer_load_dwordx4 v242, s[44:47], s86 offen lds
    v_mfma_f32_16x16x32_bf16 v[136:139], a[76:79], a[80:83], v[136:139]
    s_cmp_eq_u32 s81, 4
    s_cbranch_scc1 L_xd_s4
L_nx_s4:
    s_waitcnt lgkmcnt(1)
    v_mfma_f32_16x16x32_bf16 v[156:159], a[64:67], a[84:87], v[156:159]
    ds_read_b128 a[92:95], v203 offset:22528
    v_mfma_f32_16x16x32_bf16 v[160:163], a[68:71], a[84:87], v[160:163]
    v_mfma_f32_16x16x32_bf16 v[164:167], a[72:75], a[84:87], v[164:167]
    buffer_load_dwordx4 v241, s[44:47], s86 offen offset:2048 lds
    v_mfma_f32_16x16x32_bf16 v[168:171], a[76:79], a[84:87], v[168:171]
    s_waitcnt lgkmcnt(1)
    v_mfma_f32_16x16x32_bf16 v[140:143], a[64:67], a[88:91], v[140:143]
    ds_read_b128 a[112:115], v202 offset:16384
    s_add_u32 m0, s89, 0
    v_mfma_f32_16x16x32_bf16 v[144:147], a[68:71], a[88:91], v[144:147]
    ds_read_b128 a[96:99], v247 offset:0
    s_add_u32 s88, s88, 1
    v_mfma_f32_16x16x32_bf16 v[148:151], a[72:75], a[88:91], v[148:151]
    ds_read_b128 a[100:103], v247 offset:2048
    buffer_load_dwordx4 v246, s[36:39], s87 offen lds
    v_mfma_f32_16x16x32_bf16 v[152:155], a[76:79], a[88:91], v[152:155]
    ds_read_b128 a[104:107], v247 offset:4096
    s_waitcnt lgkmcnt(4)
    v_mfma_f32_16x16x32_bf16 v[172:175], a[64:67], a[92:95], v[172:175]
    ds_read_b128 a[108:111], v247 offset:6144
    v_mfma_f32_16x16x32_bf16 v[176:179], a[68:71], a[92:95], v[176:179]
    ds_read_b128 a[116:119], v202 offset:20480
    v_mfma_f32_16x16x32_bf16 v[180:183], a[72:75], a[92:95], v[180:183]
    buffer_load_dwordx4 v246, s[36:39], s87 offen offset:2048 lds
    v_mfma_f32_16x16x32_bf16 v[184:187], a[76:79], a[92:95], v[184:187]
    s_waitcnt lgkmcnt(3)
    v_mfma_f32_16x16x32_bf16 v[124:127], a[96:99], a[112:115], v[124:127]
    ds_read_b128 a[120:123], v202 offset:18432
    s_add_u32 m0, s89, 4096
    v_mfma_f32_16x16x32_bf16 v[128:131], a[100:103], a[112:115], v[128:131]
    s_and_b32 s88, s88, 7
    s_waitcnt lgkmcnt(2)
    v_mfma_f32_16x16x32_bf16 v[132:135], a[104:107], a[112:115], v[132:135]
    buffer_load_dwordx4 v245, s[36:39], s87 offen lds
    v_mfma_f32_16x16x32_bf16 v[136:139], a[108:111], a[112:115], v[136:139]
    s_waitcnt lgkmcnt(1)
    v_mfma_f32_16x16x32_bf16 v[156:159], a[96:99], a[116:119], v[156:159]
    ds_read_b128 a[124:127], v202 offset:22528
    v_mfma_f32_16x16x32_bf16 v[160:163], a[100:103], a[116:119], v[160:163]
    v_mfma_f32_16x16x32_bf16 v[164:167], a[104:107], a[116:119], v[164:167]
    buffer_load_dwordx4 v245, s[36:39], s87 offen offset:2048 lds
    v_mfma_f32_16x16x32_bf16 v[168:171], a[108:111], a[116:119], v[168:171]
    s_waitcnt vmcnt(8)
    s_barrier
    s_waitcnt lgkmcnt(1)
    v_mfma_f32_16x16x32_bf16 v[140:143], a[96:99], a[120:123], v[140:143]
    ds_read_b128 a[80:83], v203 offset:49152
    s_add_u32 m0, s89, 49152
    v_mfma_f32_16x16x32_bf16 v[144:147], a[100:103], a[120:123], v[144:147]
    ds_read_b128 a[64:67], v248 offset:32768
    s_mul_i32 s86, s88, s83
    v_mfma_f32_16x16x32_bf16 v[148:151], a[104:107], a[120:123], v[148:151]
    ds_read_b128 a[68:71], v248 offset:34816
    buffer_load_dwordx4 v244, s[40:43], s86 offen lds
    v_mfma_f32_16x16x32_bf16 v[152:155], a[108:111], a[120:123], v[152:155]
    ds_read_b128 a[72:75], v248 offset:36864
    s_waitcnt lgkmcnt(4)
    v_mfma_f32_16x16x32_bf16 v[172:175], a[96:99], a[124:127], v[172:175]
    ds_read_b128 a[76:79], v248 offset:38912
    v_mfma_f32_16x16x32_bf16 v[176:179], a[100:103], a[124:127], v[176:179]
    ds_read_b128 a[84:87], v203 offset:53248
    v_mfma_f32_16x16x32_bf16 v[180:183], a[104:107], a[124:127], v[180:183]
    buffer_load_dwordx4 v243, s[40:43], s86 offen offset:2048 lds
    v_mfma_f32_16x16x32_bf16 v[184:187], a[108:111], a[124:127], v[184:187]
    s_waitcnt lgkmcnt(3)
    v_mfma_f32_16x16x32_bf16 v[124:127], a[64:67], a[80:83], v[124:127]
    ds_read_b128 a[88:91], v203 offset:51200
    s_add_u32 m0, s89, 53248
    v_mfma_f32_16x16x32_bf16 v[128:131], a[68:71], a[80:83], v[128:131]
    s_lshl_b32 s87, s88, 7
    s_waitcnt lgkmcnt(2)
    v_mfma_f32_16x16x32_bf16 v[132:135], a[72:75], a[80:83], v[132:135]
    buffer_load_dwordx4 v242, s[44:47], s86 offen lds
    v_mfma_f32_16x16x32_bf16 v[136:139], a[76:79], a[80:83], v[136:139]
    s_cmp_eq_u32 s81, 5
    s_cbranch_scc1 L_xd_s5
L_nx_s5:
    s_waitcnt lgkmcnt(1)
    v_mfma_f32_16x16x32_bf16 v[156:159], a[64:67], a[84:87], v[156:159]
    ds_read_b128 a[92:95], v203 offset:55296
    v_mfma_f32_16x16x32_bf16 v[160:163], a[68:71], a[84:87], v[160:163]
    v_mfma_f32_16x16x32_bf16 v[164:167], a[72:75], a[84:87], v[164:167]
    buffer_load_dwordx4 v241, s[44:47], s86 offen offset:2048 lds
    v_mfma_f32_16x16x32_bf16 v[168:171], a[76:79], a[84:87], v[168:171]
    s_waitcnt lgkmcnt(1)
    v_mfma_f32_16x16x32_bf16 v[140:143], a[64:67], a[88:91], v[140:143]
    ds_read_b128 a[112:115], v202 offset:49152
    s_add_u32 m0, s89, 32768
    v_mfma_f32_16x16x32_bf16 v[144:147], a[68:71], a[88:91], v[144:147]
    ds_read_b128 a[96:99], v247 offset:32768
    s_add_u32 s88, s88, 1
    v_mfma_f32_16x16x32_bf16 v[148:151], a[72:75], a[88:91], v[148:151]
    ds_read_b128 a[100:103], v247 offset:34816
    buffer_load_dwordx4 v246, s[36:39], s87 offen lds
    v_mfma_f32_16x16x32_bf16 v[152:155], a[76:79], a[88:91], v[152:155]
    ds_read_b128 a[104:107], v247 offset:36864
    s_waitcnt lgkmcnt(4)
    v_mfma_f32_16x16x32_bf16 v[172:175], a[64:67], a[92:95], v[172:175]
    ds_read_b128 a[108:111], v247 offset:38912
    v_mfma_f32_16x16x32_bf16 v[176:179], a[68:71], a[92:95], v[176:179]
    ds_read_b128 a[116:119], v202 offset:53248
    v_mfma_f32_16x16x32_bf16 v[180:183], a[72:75], a[92:95], v[180:183]
    buffer_load_dwordx4 v246, s[36:39], s87 offen offset:2048 lds
    v_mfma_f32_16x16x32_bf16 v[184:187], a[76:79], a[92:95], v[184:187]
    s_waitcnt lgkmcnt(3)
    v_mfma_f32_16x16x32_bf16 v[124:127], a[96:99], a[112:115], v[124:127]
    ds_read_b128 a[120:123], v202 offset:51200
    s_add_u32 m0, s89, 36864
    v_mfma_f32_16x16x32_bf16 v[128:131], a[100:103], a[112:115], v[128:131]
    ds_read_b128 a[124:127], v202 offset:55296
    s_and_b32 s88, s88, 7
    s_waitcnt lgkmcnt(3)
    v_mfma_f32_16x16x32_bf16 v[132:135], a[104:107], a[112:115], v[132:135]
    buffer_load_dwordx4 v245, s[36:39], s87 offen lds
    v_mfma_f32_16x16x32_bf16 v[136:139], a[108:111], a[112:115], v[136:139]
    s_waitcnt lgkmcnt(2)
    v_mfma_f32_16x16x32_bf16 v[156:159], a[96:99], a[116:119], v[156:159]
    v_mfma_f32_16x16x32_bf16 v[160:163], a[100:103], a[116:119], v[160:163]
    v_mfma_f32_16x16x32_bf16 v[164:167], a[104:107], a[116:119], v[164:167]
    buffer_load_dwordx4 v245, s[36:39], s87 offen offset:2048 lds
    v_mfma_f32_16x16x32_bf16 v[168:171], a[108:111], a[116:119], v[168:171]
    s_waitcnt vmcnt(8) lgkmcnt(0)
    s_barrier
    v_mfma_f32_16x16x32_bf16 v[140:143], a[96:99], a[120:123], v[140:143]
    ds_read_b128 a[80:83], v224 offset:16384
    buffer_load_dwordx4 v[68:71], v231, s[48:51], 0 offen sc1
    buffer_load_dwordx4 v[72:75], v231, s[48:51], 0 offen offset:256 sc1
    buffer_load_dwordx4 v[24:27], v230, s[48:51], 0 offen sc1
    s_add_u32 m0, s76, 131072
    v_mfma_f32_16x16x32_bf16 v[144:147], a[100:103], a[120:123], v[144:147]
    ds_read_b128 a[64:67], v251 offset:0
    s_xor_b32 s87, s32, 0
    v_mfma_f32_16x16x32_bf16 v[148:151], a[104:107], a[120:123], v[148:151]
    ds_read_b128 a[68:71], v251 offset:2048
    buffer_load_dwordx4 v223, s[60:63], s87 offen lds
    v_mfma_f32_16x16x32_bf16 v[152:155], a[108:111], a[120:123], v[152:155]
    ds_read_b128 a[72:75], v251 offset:4096
    v_mfma_f32_16x16x32_bf16 v[172:175], a[96:99], a[124:127], v[172:175]
    ds_read_b128 a[76:79], v251 offset:6144
    v_mfma_f32_16x16x32_bf16 v[176:179], a[100:103], a[124:127], v[176:179]
    ds_read_b128 a[84:87], v224 offset:20480
    v_mfma_f32_16x16x32_bf16 v[180:183], a[104:107], a[124:127], v[180:183]
    buffer_load_dwordx4 v222, s[60:63], s87 offen offset:1024 lds
    v_mfma_f32_16x16x32_bf16 v[184:187], a[108:111], a[124:127], v[184:187]
    s_waitcnt lgkmcnt(3)
    v_mfma_f32_16x16x32_bf16 v[124:127], a[64:67], a[80:83], v[124:127]
    ds_read_b128 a[88:91], v224 offset:18432
    v_mfma_f32_16x16x32_bf16 v[128:131], a[68:71], a[80:83], v[128:131]
    s_waitcnt lgkmcnt(2)
    v_mfma_f32_16x16x32_bf16 v[132:135], a[72:75], a[80:83], v[132:135]
    buffer_load_dwordx4 v221, s[60:63], s87 offen offset:2048 lds
    v_mfma_f32_16x16x32_bf16 v[136:139], a[76:79], a[80:83], v[136:139]
    s_cmp_eq_u32 s81, 6
    s_cbranch_scc1 L_xd_s6
L_nx_s6:
    s_waitcnt lgkmcnt(1)
    v_mfma_f32_16x16x32_bf16 v[156:159], a[64:67], a[84:87], v[156:159]
    ds_read_b128 a[92:95], v224 offset:22528
    v_mfma_f32_16x16x32_bf16 v[160:163], a[68:71], a[84:87], v[160:163]
    v_mfma_f32_16x16x32_bf16 v[164:167], a[72:75], a[84:87], v[164:167]
    buffer_load_dwordx4 v220, s[60:63], s87 offen offset:3072 lds
    v_mfma_f32_16x16x32_bf16 v[168:171], a[76:79], a[84:87], v[168:171]
    s_waitcnt lgkmcnt(1)
    v_mfma_f32_16x16x32_bf16 v[140:143], a[64:67], a[88:91], v[140:143]
    ds_read_b128 a[112:115], v204 offset:16384
    s_add_u32 m0, s76, 135168
    v_mfma_f32_16x16x32_bf16 v[144:147], a[68:71], a[88:91], v[144:147]
    ds_read_b128 a[96:99], v250 offset:0
    s_xor_b32 s87, s32, 32768
    v_mfma_f32_16x16x32_bf16 v[148:151], a[72:75], a[88:91], v[148:151]
    ds_read_b128 a[100:103], v250 offset:2048
    buffer_load_dwordx4 v223, s[60:63], s87 offen lds
    v_mfma_f32_16x16x32_bf16 v[152:155], a[76:79], a[88:91], v[152:155]
    ds_read_b128 a[104:107], v250 offset:4096
    s_waitcnt lgkmcnt(4)
    v_mfma_f32_16x16x32_bf16 v[172:175], a[64:67], a[92:95], v[172:175]
    ds_read_b128 a[108:111], v250 offset:6144
    v_mfma_f32_16x16x32_bf16 v[176:179], a[68:71], a[92:95], v[176:179]
    ds_read_b128 a[116:119], v204 offset:20480
    v_mfma_f32_16x16x32_bf16 v[180:183], a[72:75], a[92:95], v[180:183]
    buffer_load_dwordx4 v222, s[60:63], s87 offen offset:1024 lds
    v_mfma_f32_16x16x32_bf16 v[184:187], a[76:79], a[92:95], v[184:187]
    s_waitcnt lgkmcnt(3)
    v_mfma_f32_16x16x32_bf16 v[124:127], a[96:99], a[112:115], v[124:127]
    ds_read_b128 a[120:123], v204 offset:18432
    v_mfma_f32_16x16x32_bf16 v[128:131], a[100:103], a[112:115], v[128:131]
    ds_read_b128 a[124:127], v204 offset:22528
    s_waitcnt lgkmcnt(3)
    v_mfma_f32_16x16x32_bf16 v[132:135], a[104:107], a[112:115], v[132:135]
    buffer_load_dwordx4 v221, s[60:63], s87 offen offset:2048 lds
    v_mfma_f32_16x16x32_bf16 v[136:139], a[108:111], a[112:115], v[136:139]
    s_waitcnt lgkmcnt(2)
    v_mfma_f32_16x16x32_bf16 v[156:159], a[96:99], a[116:119], v[156:159]
    v_mfma_f32_16x16x32_bf16 v[160:163], a[100:103], a[116:119], v[160:163]
    v_mfma_f32_16x16x32_bf16 v[164:167], a[104:107], a[116:119], v[164:167]
    buffer_load_dwordx4 v220, s[60:63], s87 offen offset:3072 lds
    v_mfma_f32_16x16x32_bf16 v[168:171], a[108:111], a[116:119], v[168:171]
    s_waitcnt vmcnt(11) lgkmcnt(0)
    s_barrier
    v_mfma_f32_16x16x32_bf16 v[140:143], a[96:99], a[120:123], v[140:143]
    ds_read_b128 a[80:83], v224 offset:49152
    v_mfma_f32_16x16x32_bf16 v[144:147], a[100:103], a[120:123], v[144:147]
    ds_read_b128 a[64:67], v251 offset:32768
    v_mfma_f32_16x16x32_bf16 v[148:151], a[104:107], a[120:123], v[148:151]
    ds_read_b128 a[68:71], v251 offset:34816
    v_mfma_f32_16x16x32_bf16 v[152:155], a[108:111], a[120:123], v[152:155]
    ds_read_b128 a[72:75], v251 offset:36864
    v_mfma_f32_16x16x32_bf16 v[172:175], a[96:99], a[124:127], v[172:175]
    ds_read_b128 a[76:79], v251 offset:38912
    v_mfma_f32_16x16x32_bf16 v[176:179], a[100:103], a[124:127], v[176:179]
    ds_read_b128 a[84:87], v224 offset:53248
    v_mfma_f32_16x16x32_bf16 v[180:183], a[104:107], a[124:127], v[180:183]
    v_mfma_f32_16x16x32_bf16 v[184:187], a[108:111], a[124:127], v[184:187]
    s_waitcnt lgkmcnt(3)
    v_mfma_f32_16x16x32_bf16 v[124:127], a[64:67], a[80:83], v[124:127]
    ds_read_b128 a[88:91], v224 offset:51200
    v_mfma_f32_16x16x32_bf16 v[128:131], a[68:71], a[80:83], v[128:131]
    s_waitcnt lgkmcnt(2)
    v_mfma_f32_16x16x32_bf16 v[132:135], a[72:75], a[80:83], v[132:135]
    v_mfma_f32_16x16x32_bf16 v[136:139], a[76:79], a[80:83], v[136:139]
    s_cmp_eq_u32 s81, 7
    s_cbranch_scc1 L_xd_s7
L_nx_s7:
    s_waitcnt lgkmcnt(1)
    v_mfma_f32_16x16x32_bf16 v[156:159], a[64:67], a[84:87], v[156:159]
    ds_read_b128 a[92:95], v224 offset:55296
    v_mfma_f32_16x16x32_bf16 v[160:163], a[68:71], a[84:87], v[160:163]
    v_mfma_f32_16x16x32_bf16 v[164:167], a[72:75], a[84:87], v[164:167]
    v_mfma_f32_16x16x32_bf16 v[168:171], a[76:79], a[84:87], v[168:171]
    s_waitcnt lgkmcnt(1)
    v_mfma_f32_16x16x32_bf16 v[140:143], a[64:67], a[88:91], v[140:143]
    ds_read_b128 a[112:115], v204 offset:49152
    v_mfma_f32_16x16x32_bf16 v[144:147], a[68:71], a[88:91], v[144:147]
    ds_read_b128 a[96:99], v250 offset:32768
    v_mfma_f32_16x16x32_bf16 v[148:151], a[72:75], a[88:91], v[148:151]
    ds_read_b128 a[100:103], v250 offset:34816
    v_mfma_f32_16x16x32_bf16 v[152:155], a[76:79], a[88:91], v[152:155]
    ds_read_b128 a[104:107], v250 offset:36864
    s_waitcnt lgkmcnt(4)
    v_mfma_f32_16x16x32_bf16 v[172:175], a[64:67], a[92:95], v[172:175]
    ds_read_b128 a[108:111], v250 offset:38912
    v_mfma_f32_16x16x32_bf16 v[176:179], a[68:71], a[92:95], v[176:179]
    ds_read_b128 a[116:119], v204 offset:53248
    v_mfma_f32_16x16x32_bf16 v[180:183], a[72:75], a[92:95], v[180:183]
    v_mfma_f32_16x16x32_bf16 v[184:187], a[76:79], a[92:95], v[184:187]
    s_waitcnt lgkmcnt(3)
    v_mfma_f32_16x16x32_bf16 v[124:127], a[96:99], a[112:115], v[124:127]
    ds_read_b128 a[120:123], v204 offset:51200
    v_mfma_f32_16x16x32_bf16 v[128:131], a[100:103], a[112:115], v[128:131]
    s_waitcnt lgkmcnt(2)
    v_mfma_f32_16x16x32_bf16 v[132:135], a[104:107], a[112:115], v[132:135]
    v_mfma_f32_16x16x32_bf16 v[136:139], a[108:111], a[112:115], v[136:139]
    s_waitcnt lgkmcnt(1)
    v_mfma_f32_16x16x32_bf16 v[156:159], a[96:99], a[116:119], v[156:159]
    ds_read_b128 a[124:127], v204 offset:55296
    v_mfma_f32_16x16x32_bf16 v[160:163], a[100:103], a[116:119], v[160:163]
    v_mfma_f32_16x16x32_bf16 v[164:167], a[104:107], a[116:119], v[164:167]
    v_mfma_f32_16x16x32_bf16 v[168:171], a[108:111], a[116:119], v[168:171]
    s_waitcnt lgkmcnt(1)
    v_mfma_f32_16x16x32_bf16 v[140:143], a[96:99], a[120:123], v[140:143]
    v_mfma_f32_16x16x32_bf16 v[144:147], a[100:103], a[120:123], v[144:147]
    v_mfma_f32_16x16x32_bf16 v[148:151], a[104:107], a[120:123], v[148:151]
    v_mfma_f32_16x16x32_bf16 v[152:155], a[108:111], a[120:123], v[152:155]
    s_waitcnt lgkmcnt(0)
    v_mfma_f32_16x16x32_bf16 v[172:175], a[96:99], a[124:127], v[172:175]
    v_mfma_f32_16x16x32_bf16 v[176:179], a[100:103], a[124:127], v[176:179]
    v_mfma_f32_16x16x32_bf16 v[180:183], a[104:107], a[124:127], v[180:183]
    v_mfma_f32_16x16x32_bf16 v[184:187], a[108:111], a[124:127], v[184:187]
    s_xor_b32 m0, s75, 65536
    s_xor_b32 s87, s33, 0
    buffer_load_dwordx4 v219, s[56:59], s87 offen lds
    buffer_load_dwordx4 v218, s[56:59], s87 offen offset:2048 lds
    s_xor_b32 m0, s75, 73728
    s_xor_b32 s87, s33, 128
    buffer_load_dwordx4 v219, s[56:59], s87 offen lds
    buffer_load_dwordx4 v218, s[56:59], s87 offen offset:2048 lds
    s_xor_b32 m0, s75, 81920
    s_xor_b32 s87, s33, 256
    buffer_load_dwordx4 v219, s[56:59], s87 offen lds
    buffer_load_dwordx4 v218, s[56:59], s87 offen offset:2048 lds
    s_xor_b32 m0, s75, 90112
    s_xor_b32 s87, s33, 384
    buffer_load_dwordx4 v219, s[56:59], s87 offen lds
    buffer_load_dwordx4 v218, s[56:59], s87 offen offset:2048 lds
    v_pk_fma_f32 v[40:41], v[76:77], v[124:125], v[126:127] op_sel_hi:[0,1,1]
    v_pk_fma_f32 v[42:43], v[76:77], v[156:157], v[158:159] op_sel_hi:[0,1,1]
    v_pk_fma_f32 v[40:41], v[78:79], v[156:157], v[40:41] op_sel_hi:[0,1,1] neg_lo:[1,0,0] neg_hi:[1,0,0]
    v_pk_fma_f32 v[42:43], v[78:79], v[124:125], v[42:43] op_sel_hi:[0,1,1]
    v_pk_fma_f32 v[36:37], v[76:77], v[40:41], v[128:129] op_sel_hi:[0,1,1]
    v_pk_fma_f32 v[38:39], v[76:77], v[42:43], v[160:161] op_sel_hi:[0,1,1]
    v_pk_fma_f32 v[36:37], v[78:79], v[42:43], v[36:37] op_sel_hi:[0,1,1] neg_lo:[1,0,0] neg_hi:[1,0,0]
    v_pk_fma_f32 v[38:39], v[78:79], v[40:41], v[38:39] op_sel_hi:[0,1,1]
    v_pk_fma_f32 v[40:41], v[76:77], v[36:37], v[130:131] op_sel_hi:[0,1,1]
    v_pk_fma_f32 v[42:43], v[76:77], v[38:39], v[162:163] op_sel_hi:[0,1,1]
    v_pk_fma_f32 v[40:41], v[78:79], v[38:39], v[40:41] op_sel_hi:[0,1,1] neg_lo:[1,0,0] neg_hi:[1,0,0]
    v_pk_fma_f32 v[42:43], v[78:79], v[36:37], v[42:43] op_sel_hi:[0,1,1]
    v_pk_fma_f32 v[36:37], v[76:77], v[40:41], v[132:133] op_sel_hi:[0,1,1]
    v_pk_fma_f32 v[38:39], v[76:77], v[42:43], v[164:165] op_sel_hi:[0,1,1]
    v_pk_fma_f32 v[36:37], v[78:79], v[42:43], v[36:37] op_sel_hi:[0,1,1] neg_lo:[1,0,0] neg_hi:[1,0,0]
    v_pk_fma_f32 v[38:39], v[78:79], v[40:41], v[38:39] op_sel_hi:[0,1,1]
    v_pk_fma_f32 v[40:41], v[76:77], v[36:37], v[134:135] op_sel_hi:[0,1,1]
    v_pk_fma_f32 v[42:43], v[76:77], v[38:39], v[166:167] op_sel_hi:[0,1,1]
    v_pk_fma_f32 v[40:41], v[78:79], v[38:39], v[40:41] op_sel_hi:[0,1,1] neg_lo:[1,0,0] neg_hi:[1,0,0]
    v_pk_fma_f32 v[42:43], v[78:79], v[36:37], v[42:43] op_sel_hi:[0,1,1]
    v_pk_fma_f32 v[36:37], v[76:77], v[40:41], v[136:137] op_sel_hi:[0,1,1]
    v_pk_fma_f32 v[38:39], v[76:77], v[42:43], v[168:169] op_sel_hi:[0,1,1]
    v_pk_fma_f32 v[36:37], v[78:79], v[42:43], v[36:37] op_sel_hi:[0,1,1] neg_lo:[1,0,0] neg_hi:[1,0,0]
    v_pk_fma_f32 v[38:39], v[78:79], v[40:41], v[38:39] op_sel_hi:[0,1,1]
    v_pk_fma_f32 v[40:41], v[76:77], v[36:37], v[138:139] op_sel_hi:[0,1,1]
L_pg1264:
    s_cbranch_execz L_backs
    v_pk_fma_f32 v[42:43], v[76:77], v[38:39], v[170:171] op_sel_hi:[0,1,1]
    v_pk_fma_f32 v[40:41], v[78:79], v[38:39], v[40:41] op_sel_hi:[0,1,1] neg_lo:[1,0,0] neg_hi:[1,0,0]
    v_pk_fma_f32 v[42:43], v[78:79], v[36:37], v[42:43] op_sel_hi:[0,1,1]
    v_pk_fma_f32 v[48:49], v[76:77], v[140:141], v[142:143] op_sel:[1,0,0]
    v_pk_fma_f32 v[50:51], v[76:77], v[172:173], v[174:175] op_sel:[1,0,0]
    v_pk_fma_f32 v[48:49], v[78:79], v[172:173], v[48:49] op_sel:[1,0,0] neg_lo:[1,0,0] neg_hi:[1,0,0]
    v_pk_fma_f32 v[50:51], v[78:79], v[140:141], v[50:51] op_sel:[1,0,0]
    v_pk_fma_f32 v[44:45], v[76:77], v[48:49], v[144:145] op_sel:[1,0,0]
    v_pk_fma_f32 v[46:47], v[76:77], v[50:51], v[176:177] op_sel:[1,0,0]
    v_pk_fma_f32 v[44:45], v[78:79], v[50:51], v[44:45] op_sel:[1,0,0] neg_lo:[1,0,0] neg_hi:[1,0,0]
    v_pk_fma_f32 v[46:47], v[78:79], v[48:49], v[46:47] op_sel:[1,0,0]
    v_pk_fma_f32 v[48:49], v[76:77], v[44:45], v[146:147] op_sel:[1,0,0]
    v_pk_fma_f32 v[50:51], v[76:77], v[46:47], v[178:179] op_sel:[1,0,0]
    v_pk_fma_f32 v[48:49], v[78:79], v[46:47], v[48:49] op_sel:[1,0,0] neg_lo:[1,0,0] neg_hi:[1,0,0]
    v_pk_fma_f32 v[50:51], v[78:79], v[44:45], v[50:51] op_sel:[1,0,0]
    v_pk_fma_f32 v[44:45], v[76:77], v[48:49], v[148:149] op_sel:[1,0,0]
    v_pk_fma_f32 v[46:47], v[76:77], v[50:51], v[180:181] op_sel:[1,0,0]
    v_pk_fma_f32 v[44:45], v[78:79], v[50:51], v[44:45] op_sel:[1,0,0] neg_lo:[1,0,0] neg_hi:[1,0,0]
    v_pk_fma_f32 v[46:47], v[78:79], v[48:49], v[46:47] op_sel:[1,0,0]
    v_pk_fma_f32 v[48:49], v[76:77], v[44:45], v[150:151] op_sel:[1,0,0]
    v_pk_fma_f32 v[50:51], v[76:77], v[46:47], v[182:183] op_sel:[1,0,0]
    v_pk_fma_f32 v[48:49], v[78:79], v[46:47], v[48:49] op_sel:[1,0,0] neg_lo:[1,0,0] neg_hi:[1,0,0]
    v_pk_fma_f32 v[50:51], v[78:79], v[44:45], v[50:51] op_sel:[1,0,0]
    v_pk_fma_f32 v[44:45], v[76:77], v[48:49], v[152:153] op_sel:[1,0,0]
    v_pk_fma_f32 v[46:47], v[76:77], v[50:51], v[184:185] op_sel:[1,0,0]
    v_pk_fma_f32 v[44:45], v[78:79], v[50:51], v[44:45] op_sel:[1,0,0] neg_lo:[1,0,0] neg_hi:[1,0,0]
    v_pk_fma_f32 v[46:47], v[78:79], v[48:49], v[46:47] op_sel:[1,0,0]
    v_pk_fma_f32 v[48:49], v[76:77], v[44:45], v[154:155] op_sel:[1,0,0]
    v_pk_fma_f32 v[50:51], v[76:77], v[46:47], v[186:187] op_sel:[1,0,0]
    v_pk_fma_f32 v[48:49], v[78:79], v[46:47], v[48:49] op_sel:[1,0,0] neg_lo:[1,0,0] neg_hi:[1,0,0]
    v_pk_fma_f32 v[50:51], v[78:79], v[44:45], v[50:51] op_sel:[1,0,0]
    v_fma_f32 v36, v84, v40, v41
    v_fma_f32 v38, v84, v42, v43
    v_fma_f32 v36, -v86, v42, v36
    v_fmac_f32 v38, v86, v40
    v_fma_f32 v37, v85, v48, v49
    v_fma_f32 v39, v85, v50, v51
    v_fma_f32 v37, -v87, v50, v37
    v_fmac_f32 v39, v87, v48
    v_pk_mov_b32 v[44:45], v[36:37], v[36:37] op_sel:[0,1]
    v_pk_mov_b32 v[46:47], v[38:39], v[38:39] op_sel:[0,1]
    s_nop 0
    v_permlane16_swap_b32 v36, v44
    v_permlane16_swap_b32 v37, v45
    v_permlane16_swap_b32 v38, v46
    v_permlane16_swap_b32 v39, v47
    v_pk_fma_f32 v[52:53], v[88:89], v[36:37], v[44:45]
    v_pk_fma_f32 v[54:55], v[88:89], v[38:39], v[46:47]
    v_pk_fma_f32 v[52:53], v[90:91], v[38:39], v[52:53] neg_lo:[1,0,0] neg_hi:[1,0,0]
    v_pk_fma_f32 v[54:55], v[90:91], v[36:37], v[54:55]
    v_pk_mov_b32 v[56:57], v[52:53], v[52:53] op_sel:[0,1]
    v_pk_mov_b32 v[58:59], v[54:55], v[54:55] op_sel:[0,1]
    s_nop 0
    v_permlane32_swap_b32 v52, v56
    v_permlane32_swap_b32 v53, v57
    v_permlane32_swap_b32 v54, v58
    v_permlane32_swap_b32 v55, v59
    v_pk_fma_f32 v[60:61], v[92:93], v[52:53], v[56:57]
    v_pk_fma_f32 v[62:63], v[92:93], v[54:55], v[58:59]
    v_pk_fma_f32 v[60:61], v[94:95], v[54:55], v[60:61] neg_lo:[1,0,0] neg_hi:[1,0,0]
    v_pk_fma_f32 v[62:63], v[94:95], v[52:53], v[62:63]
    ds_write_b128 v198, v[60:63]
    v_and_b32 v198, 0xfffffdff, v198
    s_mov_b32 s80, 0x7060500
    s_mov_b32 s79, 0x7060501
    s_mov_b32 s78, 0x7060502
    s_mov_b32 s77, 0x7060503
    s_waitcnt vmcnt(8)
    s_waitcnt lgkmcnt(0)
    s_barrier
    ds_read_b128 v[64:67], v198
    s_waitcnt lgkmcnt(0)
    v_pk_fma_f32 v[234:235], v[96:97], v[64:65], v[60:61]
    v_pk_fma_f32 v[236:237], v[96:97], v[66:67], v[62:63]
    v_pk_fma_f32 v[234:235], v[98:99], v[66:67], v[234:235] neg_lo:[1,0,0] neg_hi:[1,0,0]
    v_pk_fma_f32 v[236:237], v[98:99], v[64:65], v[236:237]
    v_perm_b32 v234, v234, v240, s80
    v_perm_b32 v235, v235, v240, s79
    v_perm_b32 v236, v236, v240, s78
    v_perm_b32 v237, v237, v240, s77
    buffer_store_dwordx4 v[234:237], v199, s[68:71], 0 offen sc1
    s_bfe_u32 s80, s85, 0x80000
    s_xor_b32 m0, s75, 0
    s_xor_b32 s87, s33, 0
    buffer_load_dwordx4 v219, s[52:55], s87 offen lds
    ds_read_b64_tr_b16 a[0:1], v217 offset:0
    s_bfe_u32 s79, s85, 0x80008
    s_bfe_u32 s78, s85, 0x80010
    s_bfe_u32 s77, s85, 0x80018
    ds_read_b64_tr_b16 a[2:3], v217 offset:2048
    v_cndmask_b32 v64, 0, v64, s[18:19]
    v_cndmask_b32 v65, 0, v65, s[18:19]
    v_cndmask_b32 v66, 0, v66, s[18:19]
    v_cndmask_b32 v67, 0, v67, s[18:19]
    ds_read_b64_tr_b16 a[4:5], v216 offset:0
    v_cndmask_b32 v52, 0, v52, s[20:21]
    v_cndmask_b32 v53, 0, v53, s[20:21]
    v_cndmask_b32 v54, 0, v54, s[20:21]
    ds_read_b64_tr_b16 a[6:7], v216 offset:2048
    v_cndmask_b32 v55, 0, v55, s[20:21]
    v_cndmask_b32 v36, 0, v36, s[22:23]
    v_cndmask_b32 v37, 0, v37, s[22:23]
    v_cndmask_b32 v38, 0, v38, s[22:23]
    buffer_load_dwordx4 v218, s[52:55], s87 offen offset:2048 lds
    ds_read_b64_tr_b16 a[8:9], v215 offset:0
    v_cndmask_b32 v39, 0, v39, s[22:23]
    v_pk_fma_f32 v[56:57], v[112:113], v[64:65], v[52:53]
    v_pk_fma_f32 v[58:59], v[112:113], v[66:67], v[54:55]
    ds_read_b64_tr_b16 a[10:11], v215 offset:2048
    v_pk_fma_f32 v[56:57], v[114:115], v[66:67], v[56:57] neg_lo:[1,0,0] neg_hi:[1,0,0]
    v_pk_fma_f32 v[58:59], v[114:115], v[64:65], v[58:59]
    v_pk_fma_f32 v[44:45], v[108:109], v[56:57], v[36:37]
    v_pk_fma_f32 v[46:47], v[108:109], v[58:59], v[38:39]
    ds_read_b64_tr_b16 a[12:13], v214 offset:0
    v_pk_fma_f32 v[44:45], v[110:111], v[58:59], v[44:45] neg_lo:[1,0,0] neg_hi:[1,0,0]
    v_pk_fma_f32 v[46:47], v[110:111], v[56:57], v[46:47]
    v_mul_f32 v88, v80, v44
    ds_read_b64_tr_b16 a[14:15], v214 offset:2048
    v_mul_f32 v90, v80, v46
    v_fma_f32 v88, -v82, v46, v88
    v_fmac_f32 v90, v82, v44
    v_fma_f32 v60, v84, v44, v40
    s_xor_b32 m0, s75, 8192
    s_xor_b32 s87, s33, 128
    buffer_load_dwordx4 v219, s[52:55], s87 offen lds
    ds_read_b64_tr_b16 a[16:17], v217 offset:4096
    v_fma_f32 v61, v84, v46, v42
    v_fma_f32 v60, -v86, v46, v60
    v_fmac_f32 v61, v86, v44
    ds_read_b64_tr_b16 a[18:19], v217 offset:6144
    v_mul_f32 v89, v80, v60
    v_mul_f32 v91, v80, v61
    v_fma_f32 v89, -v82, v61, v89
    v_fmac_f32 v91, v82, v60
    ds_read_b64_tr_b16 a[20:21], v216 offset:4096
    v_mul_f32 v92, v81, v45
    v_mul_f32 v94, v81, v47
    v_fma_f32 v92, -v83, v47, v92
    ds_read_b64_tr_b16 a[22:23], v216 offset:6144
    v_fmac_f32 v94, v83, v45
    v_fma_f32 v60, v85, v45, v48
    v_fma_f32 v61, v85, v47, v50
    v_fma_f32 v60, -v87, v47, v60
    buffer_load_dwordx4 v218, s[52:55], s87 offen offset:2048 lds
    ds_read_b64_tr_b16 a[24:25], v215 offset:4096
    v_fmac_f32 v61, v87, v45
    v_mul_f32 v93, v81, v60
    v_mul_f32 v95, v81, v61
    ds_read_b64_tr_b16 a[26:27], v215 offset:6144
    v_fma_f32 v93, -v83, v61, v93
    v_fmac_f32 v95, v83, v60
    v_pk_mul_f32 v[64:65], v[82:83], v[124:125] op_sel_hi:[0,1]
    v_pk_mul_f32 v[124:125], v[80:81], v[124:125] op_sel_hi:[0,1]
    ds_read_b64_tr_b16 a[28:29], v214 offset:4096
    v_pk_fma_f32 v[124:125], v[82:83], v[156:157], v[124:125] op_sel_hi:[0,1,1] neg_lo:[1,0,0] neg_hi:[1,0,0]
    v_pk_fma_f32 v[156:157], v[80:81], v[156:157], v[64:65] op_sel_hi:[0,1,1]
    v_pk_mul_f32 v[64:65], v[82:83], v[126:127] op_sel_hi:[0,1]
    ds_read_b64_tr_b16 a[30:31], v214 offset:6144
    v_pk_mul_f32 v[126:127], v[80:81], v[126:127] op_sel_hi:[0,1]
    v_pk_fma_f32 v[126:127], v[82:83], v[158:159], v[126:127] op_sel_hi:[0,1,1] neg_lo:[1,0,0] neg_hi:[1,0,0]
    v_pk_fma_f32 v[158:159], v[80:81], v[158:159], v[64:65] op_sel_hi:[0,1,1]
    v_pk_mul_f32 v[64:65], v[82:83], v[128:129] op_sel_hi:[0,1]
    s_xor_b32 m0, s75, 16384
    s_xor_b32 s87, s33, 256
    buffer_load_dwordx4 v219, s[52:55], s87 offen lds
    ds_read_b64_tr_b16 a[32:33], v217 offset:8192
    v_pk_mul_f32 v[128:129], v[80:81], v[128:129] op_sel_hi:[0,1]
    v_pk_fma_f32 v[128:129], v[82:83], v[160:161], v[128:129] op_sel_hi:[0,1,1] neg_lo:[1,0,0] neg_hi:[1,0,0]
    v_pk_fma_f32 v[160:161], v[80:81], v[160:161], v[64:65] op_sel_hi:[0,1,1]
    ds_read_b64_tr_b16 a[34:35], v217 offset:10240
    v_pk_mul_f32 v[64:65], v[82:83], v[130:131] op_sel_hi:[0,1]
    v_pk_mul_f32 v[130:131], v[80:81], v[130:131] op_sel_hi:[0,1]
    v_pk_fma_f32 v[130:131], v[82:83], v[162:163], v[130:131] op_sel_hi:[0,1,1] neg_lo:[1,0,0] neg_hi:[1,0,0]
    v_pk_fma_f32 v[162:163], v[80:81], v[162:163], v[64:65] op_sel_hi:[0,1,1]
    ds_read_b64_tr_b16 a[36:37], v216 offset:8192
    v_pk_mul_f32 v[64:65], v[82:83], v[132:133] op_sel_hi:[0,1]
    v_pk_mul_f32 v[132:133], v[80:81], v[132:133] op_sel_hi:[0,1]
    v_pk_fma_f32 v[132:133], v[82:83], v[164:165], v[132:133] op_sel_hi:[0,1,1] neg_lo:[1,0,0] neg_hi:[1,0,0]
    ds_read_b64_tr_b16 a[38:39], v216 offset:10240
    v_pk_fma_f32 v[164:165], v[80:81], v[164:165], v[64:65] op_sel_hi:[0,1,1]
    v_pk_mul_f32 v[64:65], v[82:83], v[134:135] op_sel_hi:[0,1]
    v_pk_mul_f32 v[134:135], v[80:81], v[134:135] op_sel_hi:[0,1]
    v_pk_fma_f32 v[134:135], v[82:83], v[166:167], v[134:135] op_sel_hi:[0,1,1] neg_lo:[1,0,0] neg_hi:[1,0,0]
    buffer_load_dwordx4 v218, s[52:55], s87 offen offset:2048 lds
    ds_read_b64_tr_b16 a[40:41], v215 offset:8192
    v_pk_fma_f32 v[166:167], v[80:81], v[166:167], v[64:65] op_sel_hi:[0,1,1]
    v_pk_mul_f32 v[64:65], v[82:83], v[136:137] op_sel_hi:[0,1]
    v_pk_mul_f32 v[136:137], v[80:81], v[136:137] op_sel_hi:[0,1]
    ds_read_b64_tr_b16 a[42:43], v215 offset:10240
    v_pk_fma_f32 v[136:137], v[82:83], v[168:169], v[136:137] op_sel_hi:[0,1,1] neg_lo:[1,0,0] neg_hi:[1,0,0]
    v_pk_fma_f32 v[168:169], v[80:81], v[168:169], v[64:65] op_sel_hi:[0,1,1]
    v_pk_mul_f32 v[64:65], v[82:83], v[138:139] op_sel_hi:[0,1]
    v_pk_mul_f32 v[138:139], v[80:81], v[138:139] op_sel_hi:[0,1]
    ds_read_b64_tr_b16 a[44:45], v214 offset:8192
    v_pk_fma_f32 v[138:139], v[82:83], v[170:171], v[138:139] op_sel_hi:[0,1,1] neg_lo:[1,0,0] neg_hi:[1,0,0]
    v_pk_fma_f32 v[170:171], v[80:81], v[170:171], v[64:65] op_sel_hi:[0,1,1]
    v_pk_mul_f32 v[64:65], v[82:83], v[140:141] op_sel:[1,0]
    ds_read_b64_tr_b16 a[46:47], v214 offset:10240
    v_pk_mul_f32 v[140:141], v[80:81], v[140:141] op_sel:[1,0]
    v_pk_fma_f32 v[140:141], v[82:83], v[172:173], v[140:141] op_sel:[1,0,0] neg_lo:[1,0,0] neg_hi:[1,0,0]
    v_pk_fma_f32 v[172:173], v[80:81], v[172:173], v[64:65] op_sel:[1,0,0]
    v_pk_mul_f32 v[64:65], v[82:83], v[142:143] op_sel:[1,0]
    s_xor_b32 m0, s75, 24576
    s_xor_b32 s87, s33, 384
    buffer_load_dwordx4 v219, s[52:55], s87 offen lds
    ds_read_b64_tr_b16 a[48:49], v217 offset:12288
    v_pk_mul_f32 v[142:143], v[80:81], v[142:143] op_sel:[1,0]
    v_pk_fma_f32 v[142:143], v[82:83], v[174:175], v[142:143] op_sel:[1,0,0] neg_lo:[1,0,0] neg_hi:[1,0,0]
    v_pk_fma_f32 v[174:175], v[80:81], v[174:175], v[64:65] op_sel:[1,0,0]
    ds_read_b64_tr_b16 a[50:51], v217 offset:14336
    v_pk_mul_f32 v[64:65], v[82:83], v[144:145] op_sel:[1,0]
    v_pk_mul_f32 v[144:145], v[80:81], v[144:145] op_sel:[1,0]
    v_pk_fma_f32 v[144:145], v[82:83], v[176:177], v[144:145] op_sel:[1,0,0] neg_lo:[1,0,0] neg_hi:[1,0,0]
    v_pk_fma_f32 v[176:177], v[80:81], v[176:177], v[64:65] op_sel:[1,0,0]
    ds_read_b64_tr_b16 a[52:53], v216 offset:12288
    v_pk_mul_f32 v[64:65], v[82:83], v[146:147] op_sel:[1,0]
    v_pk_mul_f32 v[146:147], v[80:81], v[146:147] op_sel:[1,0]
    v_pk_fma_f32 v[146:147], v[82:83], v[178:179], v[146:147] op_sel:[1,0,0] neg_lo:[1,0,0] neg_hi:[1,0,0]
    ds_read_b64_tr_b16 a[54:55], v216 offset:14336
    v_pk_fma_f32 v[178:179], v[80:81], v[178:179], v[64:65] op_sel:[1,0,0]
    v_pk_mul_f32 v[64:65], v[82:83], v[148:149] op_sel:[1,0]
    v_pk_mul_f32 v[148:149], v[80:81], v[148:149] op_sel:[1,0]
    v_pk_fma_f32 v[148:149], v[82:83], v[180:181], v[148:149] op_sel:[1,0,0] neg_lo:[1,0,0] neg_hi:[1,0,0]
    buffer_load_dwordx4 v218, s[52:55], s87 offen offset:2048 lds
    ds_read_b64_tr_b16 a[56:57], v215 offset:12288
    v_pk_fma_f32 v[180:181], v[80:81], v[180:181], v[64:65] op_sel:[1,0,0]
    v_pk_mul_f32 v[64:65], v[82:83], v[150:151] op_sel:[1,0]
    v_pk_mul_f32 v[150:151], v[80:81], v[150:151] op_sel:[1,0]
    ds_read_b64_tr_b16 a[58:59], v215 offset:14336
    v_pk_fma_f32 v[150:151], v[82:83], v[182:183], v[150:151] op_sel:[1,0,0] neg_lo:[1,0,0] neg_hi:[1,0,0]
    v_pk_fma_f32 v[182:183], v[80:81], v[182:183], v[64:65] op_sel:[1,0,0]
    v_pk_mul_f32 v[64:65], v[82:83], v[152:153] op_sel:[1,0]
    v_pk_mul_f32 v[152:153], v[80:81], v[152:153] op_sel:[1,0]
    ds_read_b64_tr_b16 a[60:61], v214 offset:12288
    v_pk_fma_f32 v[152:153], v[82:83], v[184:185], v[152:153] op_sel:[1,0,0] neg_lo:[1,0,0] neg_hi:[1,0,0]
    v_pk_fma_f32 v[184:185], v[80:81], v[184:185], v[64:65] op_sel:[1,0,0]
    v_pk_mul_f32 v[64:65], v[82:83], v[154:155] op_sel:[1,0]
    ds_read_b64_tr_b16 a[62:63], v214 offset:14336
    v_pk_mul_f32 v[154:155], v[80:81], v[154:155] op_sel:[1,0]
    v_pk_fma_f32 v[154:155], v[82:83], v[186:187], v[154:155] op_sel:[1,0,0] neg_lo:[1,0,0] neg_hi:[1,0,0]
    v_pk_fma_f32 v[186:187], v[80:81], v[186:187], v[64:65] op_sel:[1,0,0]
    buffer_load_dwordx4 v[52:55], v197, s[68:71], 0 offen sc1
    buffer_load_dwordx4 v[56:59], v196, s[68:71], 0 offen sc1
    buffer_load_dwordx4 v[60:63], v195, s[68:71], 0 offen sc1
    buffer_load_dwordx4 v[64:67], v194, s[68:71], 0 offen sc1
L_gchk_ssm:
    v_xor_b32 v255, v25, v240
    v_bitop3_b32 v255, v255, v27, v240 bitop3:0xf6
    v_bitop3_b32 v255, v255, v69, v240 bitop3:0xf6
    v_bitop3_b32 v255, v255, v71, v240 bitop3:0xf6
    v_bitop3_b32 v255, v255, v73, v240 bitop3:0xf6
    v_bitop3_b32 v255, v255, v75, v240 bitop3:0xf6
    v_cmp_ne_u32 vcc, 0, v255
    s_sub_u32 s72, s72, 1
    s_cselect_b64 vcc, 0, vcc
    s_cselect_b32 s72, 0, s72
    s_cmp_lg_u64 vcc, 0
    s_cbranch_scc0 L_gok_ssm
    buffer_load_dwordx4 v[68:71], v231, s[48:51], 0 offen sc1
    buffer_load_dwordx4 v[72:75], v231, s[48:51], 0 offen offset:256 sc1
    buffer_load_dwordx4 v[24:27], v230, s[48:51], 0 offen sc1
    s_waitcnt vmcnt(0)
    s_branch L_gchk_ssm
L_gok_ssm:
    v_sub_f32 v68, 1.0, v68
    v_sub_f32 v70, 1.0, v70
    v_sub_f32 v72, 1.0, v72
    v_sub_f32 v74, 1.0, v74
    v_cvt_pk_bf16_f32 v68, v68, v68
    v_cvt_pk_bf16_f32 v70, v70, v70
    v_cvt_pk_bf16_f32 v72, v72, v72
    v_cvt_pk_bf16_f32 v74, v74, v74
    v_and_b32 v69, v201, v68
    v_and_b32 v68, v200, v68
    v_and_b32 v71, v201, v70
    v_and_b32 v70, v200, v70
    v_and_b32 v73, v201, v72
    v_and_b32 v72, v200, v72
    v_and_b32 v75, v201, v74
    v_and_b32 v74, v200, v74
    s_waitcnt lgkmcnt(0)
    s_barrier
    s_waitcnt vmcnt(0)
    s_branch L_echk
L_epoll:
    buffer_load_dwordx4 v[52:55], v197, s[68:71], 0 offen sc1
    buffer_load_dwordx4 v[56:59], v196, s[68:71], 0 offen sc1
    buffer_load_dwordx4 v[60:63], v195, s[68:71], 0 offen sc1
    buffer_load_dwordx4 v[64:67], v194, s[68:71], 0 offen sc1
    s_waitcnt vmcnt(0)
L_echk:
    v_bitop3_b32 v52, v52, v193, s80 bitop3:0xd2
    v_bitop3_b32 v53, v53, v193, s79 bitop3:0xd2
    v_bitop3_b32 v54, v54, v193, s78 bitop3:0xd2
    v_bitop3_b32 v55, v55, v193, s77 bitop3:0xd2
    v_or_b32 v255, v52, v53
    v_or3_b32 v255, v255, v54, v55
    v_bitop3_b32 v56, v56, v192, s80 bitop3:0xd2
    v_bitop3_b32 v57, v57, v192, s79 bitop3:0xd2
    v_bitop3_b32 v58, v58, v192, s78 bitop3:0xd2
    v_bitop3_b32 v59, v59, v192, s77 bitop3:0xd2
    v_or3_b32 v255, v255, v56, v57
    v_or3_b32 v255, v255, v58, v59
    v_bitop3_b32 v60, v60, v191, s80 bitop3:0xd2
    v_bitop3_b32 v61, v61, v191, s79 bitop3:0xd2
    v_bitop3_b32 v62, v62, v191, s78 bitop3:0xd2
    v_bitop3_b32 v63, v63, v191, s77 bitop3:0xd2
    v_or3_b32 v255, v255, v60, v61
    v_or3_b32 v255, v255, v62, v63
    v_bitop3_b32 v64, v64, v190, s80 bitop3:0xd2
    v_bitop3_b32 v65, v65, v190, s79 bitop3:0xd2
    v_bitop3_b32 v66, v66, v190, s78 bitop3:0xd2
    v_bitop3_b32 v67, v67, v190, s77 bitop3:0xd2
    v_or3_b32 v255, v255, v64, v65
    v_or3_b32 v255, v255, v66, v67
    v_and_b32 v255, 0xff, v255
    v_cmp_ne_u32 vcc, 0, v255
    s_sub_u32 s72, s72, 1
    s_cselect_b64 vcc, 0, vcc
    s_cselect_b32 s72, 0, s72
    s_cmp_lg_u64 vcc, 0
    s_cbranch_scc1 L_epoll
    v_pk_fma_f32 v[60:61], v[100:101], v[64:65], v[60:61]
    v_pk_fma_f32 v[62:63], v[100:101], v[66:67], v[62:63]
    v_pk_fma_f32 v[60:61], v[102:103], v[66:67], v[60:61] neg_lo:[1,0,0] neg_hi:[1,0,0]
    v_pk_fma_f32 v[62:63], v[102:103], v[64:65], v[62:63]
    v_pk_fma_f32 v[56:57], v[100:101], v[60:61], v[56:57]
    v_pk_fma_f32 v[58:59], v[100:101], v[62:63], v[58:59]
    v_pk_fma_f32 v[56:57], v[102:103], v[62:63], v[56:57] neg_lo:[1,0,0] neg_hi:[1,0,0]
    v_pk_fma_f32 v[58:59], v[102:103], v[60:61], v[58:59]
    v_pk_fma_f32 v[52:53], v[100:101], v[56:57], v[52:53]
    v_pk_fma_f32 v[54:55], v[100:101], v[58:59], v[54:55]
    v_pk_fma_f32 v[52:53], v[102:103], v[58:59], v[52:53] neg_lo:[1,0,0] neg_hi:[1,0,0]
    v_pk_fma_f32 v[54:55], v[102:103], v[56:57], v[54:55]
    v_pk_mul_f32 v[36:37], v[104:105], v[52:53]
    v_pk_mul_f32 v[38:39], v[104:105], v[54:55]
    v_pk_fma_f32 v[36:37], v[106:107], v[54:55], v[36:37] neg_lo:[1,0,0] neg_hi:[1,0,0]
    v_pk_fma_f32 v[38:39], v[106:107], v[52:53], v[38:39]
    v_pk_mov_b32 v[40:41], v[36:37], v[36:37] op_sel:[0,1]
    v_pk_mov_b32 v[42:43], v[38:39], v[38:39] op_sel:[0,1]
    s_nop 0
    v_permlane16_swap_b32 v36, v40
    v_permlane16_swap_b32 v37, v41
    v_permlane16_swap_b32 v38, v42
    v_permlane16_swap_b32 v39, v43
    v_pk_add_f32 v[36:37], v[36:37], v[40:41]
    v_pk_add_f32 v[38:39], v[38:39], v[42:43]
    v_pk_mov_b32 v[40:41], v[36:37], v[36:37] op_sel:[0,1]
    v_pk_mov_b32 v[42:43], v[38:39], v[38:39] op_sel:[0,1]
    s_nop 0
    v_permlane32_swap_b32 v36, v40
    v_permlane32_swap_b32 v37, v41
    v_permlane32_swap_b32 v38, v42
    v_permlane32_swap_b32 v39, v43
    v_pk_add_f32 v[36:37], v[36:37], v[40:41]
    v_pk_add_f32 v[38:39], v[38:39], v[42:43]
    v_pk_fma_f32 v[88:89], v[36:37], v[116:117], v[88:89] op_sel_hi:[0,1,1]
    v_pk_fma_f32 v[90:91], v[36:37], v[118:119], v[90:91] op_sel_hi:[0,1,1]
    v_pk_fma_f32 v[88:89], v[38:39], v[118:119], v[88:89] op_sel_hi:[0,1,1] neg_lo:[1,0,0] neg_hi:[1,0,0]
    v_pk_fma_f32 v[90:91], v[38:39], v[116:117], v[90:91] op_sel_hi:[0,1,1]
    v_pk_fma_f32 v[92:93], v[36:37], v[120:121], v[92:93] op_sel:[1,0,0]
    v_pk_fma_f32 v[94:95], v[36:37], v[122:123], v[94:95] op_sel:[1,0,0]
    v_pk_fma_f32 v[92:93], v[38:39], v[122:123], v[92:93] op_sel:[1,0,0] neg_lo:[1,0,0] neg_hi:[1,0,0]
    v_pk_fma_f32 v[94:95], v[38:39], v[120:121], v[94:95] op_sel:[1,0,0]
    v_pk_fma_f32 v[124:125], v[76:77], v[88:89], v[124:125] op_sel_hi:[0,1,1]
    v_pk_fma_f32 v[156:157], v[76:77], v[90:91], v[156:157] op_sel_hi:[0,1,1]
    v_pk_fma_f32 v[124:125], v[78:79], v[90:91], v[124:125] op_sel_hi:[0,1,1] neg_lo:[1,0,0] neg_hi:[1,0,0]
    v_pk_fma_f32 v[156:157], v[78:79], v[88:89], v[156:157] op_sel_hi:[0,1,1]
    v_pk_fma_f32 v[126:127], v[76:77], v[124:125], v[126:127] op_sel_hi:[0,1,1]
    v_pk_fma_f32 v[158:159], v[76:77], v[156:157], v[158:159] op_sel_hi:[0,1,1]
    v_pk_fma_f32 v[126:127], v[78:79], v[156:157], v[126:127] op_sel_hi:[0,1,1] neg_lo:[1,0,0] neg_hi:[1,0,0]
    v_pk_fma_f32 v[158:159], v[78:79], v[124:125], v[158:159] op_sel_hi:[0,1,1]
    v_cvt_pk_bf16_f32 v86, -v156, -v157
    v_cvt_pk_bf16_f32 v87, -v158, -v159
    v_cvt_pk_bf16_f32 v84, v124, v125
    v_cvt_pk_bf16_f32 v85, v126, v127
    v_pk_fma_f32 v[140:141], v[76:77], v[92:93], v[140:141] op_sel:[1,0,0]
    v_pk_fma_f32 v[172:173], v[76:77], v[94:95], v[172:173] op_sel:[1,0,0]
    v_pk_fma_f32 v[140:141], v[78:79], v[94:95], v[140:141] op_sel:[1,0,0] neg_lo:[1,0,0] neg_hi:[1,0,0]
    v_pk_fma_f32 v[172:173], v[78:79], v[92:93], v[172:173] op_sel:[1,0,0]
    v_pk_fma_f32 v[142:143], v[76:77], v[140:141], v[142:143] op_sel:[1,0,0]
    v_pk_fma_f32 v[174:175], v[76:77], v[172:173], v[174:175] op_sel:[1,0,0]
    v_pk_fma_f32 v[142:143], v[78:79], v[172:173], v[142:143] op_sel:[1,0,0] neg_lo:[1,0,0] neg_hi:[1,0,0]
    v_pk_fma_f32 v[174:175], v[78:79], v[140:141], v[174:175] op_sel:[1,0,0]
    v_mfma_f32_16x16x16_bf16 v[44:47], v[86:87], v[68:69], 0
    v_cvt_pk_bf16_f32 v98, -v172, -v173
    v_cvt_pk_bf16_f32 v99, -v174, -v175
    v_mfma_f32_16x16x16_bf16 v[36:39], v[84:85], v[68:69], 0
    v_cvt_pk_bf16_f32 v96, v140, v141
    v_cvt_pk_bf16_f32 v97, v142, v143
    v_pk_fma_f32 v[128:129], v[76:77], v[126:127], v[128:129] op_sel_hi:[0,1,1]
    v_pk_fma_f32 v[160:161], v[76:77], v[158:159], v[160:161] op_sel_hi:[0,1,1]
    v_pk_fma_f32 v[128:129], v[78:79], v[158:159], v[128:129] op_sel_hi:[0,1,1] neg_lo:[1,0,0] neg_hi:[1,0,0]
    v_pk_fma_f32 v[160:161], v[78:79], v[126:127], v[160:161] op_sel_hi:[0,1,1]
    v_pk_fma_f32 v[130:131], v[76:77], v[128:129], v[130:131] op_sel_hi:[0,1,1]
    v_pk_fma_f32 v[162:163], v[76:77], v[160:161], v[162:163] op_sel_hi:[0,1,1]
    v_pk_fma_f32 v[130:131], v[78:79], v[160:161], v[130:131] op_sel_hi:[0,1,1] neg_lo:[1,0,0] neg_hi:[1,0,0]
    v_pk_fma_f32 v[162:163], v[78:79], v[128:129], v[162:163] op_sel_hi:[0,1,1]
    v_mfma_f32_16x16x16_bf16 v[48:51], v[98:99], v[68:69], 0
    v_cvt_pk_bf16_f32 v110, -v160, -v161
    v_cvt_pk_bf16_f32 v111, -v162, -v163
    v_mfma_f32_16x16x16_bf16 v[40:43], v[96:97], v[68:69], 0
    v_cvt_pk_bf16_f32 v108, v128, v129
    v_cvt_pk_bf16_f32 v109, v130, v131
    v_pk_fma_f32 v[144:145], v[76:77], v[142:143], v[144:145] op_sel:[1,0,0]
    v_pk_fma_f32 v[176:177], v[76:77], v[174:175], v[176:177] op_sel:[1,0,0]
    v_pk_fma_f32 v[144:145], v[78:79], v[174:175], v[144:145] op_sel:[1,0,0] neg_lo:[1,0,0] neg_hi:[1,0,0]
    v_pk_fma_f32 v[176:177], v[78:79], v[142:143], v[176:177] op_sel:[1,0,0]
    v_pk_fma_f32 v[146:147], v[76:77], v[144:145], v[146:147] op_sel:[1,0,0]
    v_pk_fma_f32 v[178:179], v[76:77], v[176:177], v[178:179] op_sel:[1,0,0]
    v_pk_fma_f32 v[146:147], v[78:79], v[176:177], v[146:147] op_sel:[1,0,0] neg_lo:[1,0,0] neg_hi:[1,0,0]
    v_pk_fma_f32 v[178:179], v[78:79], v[144:145], v[178:179] op_sel:[1,0,0]
    v_mfma_f32_16x16x16_bf16 v[60:63], v[110:111], v[70:71], 0
    v_cvt_pk_bf16_f32 v114, -v176, -v177
    v_cvt_pk_bf16_f32 v115, -v178, -v179
    v_mfma_f32_16x16x16_bf16 v[52:55], v[108:109], v[70:71], 0
    v_cvt_pk_bf16_f32 v112, v144, v145
    v_cvt_pk_bf16_f32 v113, v146, v147
    v_cvt_pk_bf16_f32 v12, v44, v45
    v_cvt_pk_bf16_f32 v13, v46, v47
    v_cvt_pk_bf16_f32 v14, v48, v49
    v_cvt_pk_bf16_f32 v15, v50, v51
    buffer_store_dwordx4 v[12:15], v225, s[48:51], s16 offen sc1
    v_cvt_pk_bf16_f32 v8, v36, v37
    v_cvt_pk_bf16_f32 v9, v38, v39
    v_cvt_pk_bf16_f32 v10, v40, v41
    v_cvt_pk_bf16_f32 v11, v42, v43
    buffer_store_dwordx4 v[8:11], v225, s[48:51], s17 offen sc1
    v_pk_fma_f32 v[132:133], v[76:77], v[130:131], v[132:133] op_sel_hi:[0,1,1]
    v_pk_fma_f32 v[164:165], v[76:77], v[162:163], v[164:165] op_sel_hi:[0,1,1]
    v_pk_fma_f32 v[132:133], v[78:79], v[162:163], v[132:133] op_sel_hi:[0,1,1] neg_lo:[1,0,0] neg_hi:[1,0,0]
    v_pk_fma_f32 v[164:165], v[78:79], v[130:131], v[164:165] op_sel_hi:[0,1,1]
    v_pk_fma_f32 v[134:135], v[76:77], v[132:133], v[134:135] op_sel_hi:[0,1,1]
    v_pk_fma_f32 v[166:167], v[76:77], v[164:165], v[166:167] op_sel_hi:[0,1,1]
    v_pk_fma_f32 v[134:135], v[78:79], v[164:165], v[134:135] op_sel_hi:[0,1,1] neg_lo:[1,0,0] neg_hi:[1,0,0]
    v_pk_fma_f32 v[166:167], v[78:79], v[132:133], v[166:167] op_sel_hi:[0,1,1]
    v_mfma_f32_16x16x16_bf16 v[64:67], v[114:115], v[70:71], 0
    v_cvt_pk_bf16_f32 v86, -v164, -v165
    v_cvt_pk_bf16_f32 v87, -v166, -v167
    v_mfma_f32_16x16x16_bf16 v[56:59], v[112:113], v[70:71], 0
    v_cvt_pk_bf16_f32 v84, v132, v133
    v_cvt_pk_bf16_f32 v85, v134, v135
    v_pk_fma_f32 v[148:149], v[76:77], v[146:147], v[148:149] op_sel:[1,0,0]
    v_pk_fma_f32 v[180:181], v[76:77], v[178:179], v[180:181] op_sel:[1,0,0]
    v_pk_fma_f32 v[148:149], v[78:79], v[178:179], v[148:149] op_sel:[1,0,0] neg_lo:[1,0,0] neg_hi:[1,0,0]
    v_pk_fma_f32 v[180:181], v[78:79], v[146:147], v[180:181] op_sel:[1,0,0]
    v_pk_fma_f32 v[150:151], v[76:77], v[148:149], v[150:151] op_sel:[1,0,0]
    v_pk_fma_f32 v[182:183], v[76:77], v[180:181], v[182:183] op_sel:[1,0,0]
    v_pk_fma_f32 v[150:151], v[78:79], v[180:181], v[150:151] op_sel:[1,0,0] neg_lo:[1,0,0] neg_hi:[1,0,0]
    v_pk_fma_f32 v[182:183], v[78:79], v[148:149], v[182:183] op_sel:[1,0,0]
    v_mfma_f32_16x16x16_bf16 v[44:47], v[86:87], v[72:73], 0
    v_cvt_pk_bf16_f32 v98, -v180, -v181
    v_cvt_pk_bf16_f32 v99, -v182, -v183
    v_mfma_f32_16x16x16_bf16 v[36:39], v[84:85], v[72:73], 0
    v_cvt_pk_bf16_f32 v96, v148, v149
    v_cvt_pk_bf16_f32 v97, v150, v151
    v_cvt_pk_bf16_f32 v20, v60, v61
    v_cvt_pk_bf16_f32 v21, v62, v63
    v_cvt_pk_bf16_f32 v22, v64, v65
    v_cvt_pk_bf16_f32 v23, v66, v67
    buffer_store_dwordx4 v[20:23], v225, s[48:51], s16 offen offset:1024 sc1
    v_cvt_pk_bf16_f32 v16, v52, v53
    v_cvt_pk_bf16_f32 v17, v54, v55
    v_cvt_pk_bf16_f32 v18, v56, v57
    v_cvt_pk_bf16_f32 v19, v58, v59
    buffer_store_dwordx4 v[16:19], v225, s[48:51], s17 offen offset:1024 sc1
    v_pk_fma_f32 v[136:137], v[76:77], v[134:135], v[136:137] op_sel_hi:[0,1,1]
    v_pk_fma_f32 v[168:169], v[76:77], v[166:167], v[168:169] op_sel_hi:[0,1,1]
    v_pk_fma_f32 v[136:137], v[78:79], v[166:167], v[136:137] op_sel_hi:[0,1,1] neg_lo:[1,0,0] neg_hi:[1,0,0]
    v_pk_fma_f32 v[168:169], v[78:79], v[134:135], v[168:169] op_sel_hi:[0,1,1]
    v_pk_fma_f32 v[138:139], v[76:77], v[136:137], v[138:139] op_sel_hi:[0,1,1]
    v_pk_fma_f32 v[170:171], v[76:77], v[168:169], v[170:171] op_sel_hi:[0,1,1]
    v_pk_fma_f32 v[138:139], v[78:79], v[168:169], v[138:139] op_sel_hi:[0,1,1] neg_lo:[1,0,0] neg_hi:[1,0,0]
    v_pk_fma_f32 v[170:171], v[78:79], v[136:137], v[170:171] op_sel_hi:[0,1,1]
    v_mfma_f32_16x16x16_bf16 v[48:51], v[98:99], v[72:73], 0
    v_cvt_pk_bf16_f32 v110, -v168, -v169
    v_cvt_pk_bf16_f32 v111, -v170, -v171
    v_mfma_f32_16x16x16_bf16 v[40:43], v[96:97], v[72:73], 0
    v_cvt_pk_bf16_f32 v108, v136, v137
    v_cvt_pk_bf16_f32 v109, v138, v139
    v_pk_fma_f32 v[152:153], v[76:77], v[150:151], v[152:153] op_sel:[1,0,0]
    v_pk_fma_f32 v[184:185], v[76:77], v[182:183], v[184:185] op_sel:[1,0,0]
    v_pk_fma_f32 v[152:153], v[78:79], v[182:183], v[152:153] op_sel:[1,0,0] neg_lo:[1,0,0] neg_hi:[1,0,0]
    v_pk_fma_f32 v[184:185], v[78:79], v[150:151], v[184:185] op_sel:[1,0,0]
    v_pk_fma_f32 v[154:155], v[76:77], v[152:153], v[154:155] op_sel:[1,0,0]
    v_pk_fma_f32 v[186:187], v[76:77], v[184:185], v[186:187] op_sel:[1,0,0]
    v_pk_fma_f32 v[154:155], v[78:79], v[184:185], v[154:155] op_sel:[1,0,0] neg_lo:[1,0,0] neg_hi:[1,0,0]
    v_pk_fma_f32 v[186:187], v[78:79], v[152:153], v[186:187] op_sel:[1,0,0]
    v_mfma_f32_16x16x16_bf16 v[60:63], v[110:111], v[74:75], 0
    v_cvt_pk_bf16_f32 v114, -v184, -v185
    v_cvt_pk_bf16_f32 v115, -v186, -v187
    v_mfma_f32_16x16x16_bf16 v[52:55], v[108:109], v[74:75], 0
    v_cvt_pk_bf16_f32 v112, v152, v153
    v_cvt_pk_bf16_f32 v113, v154, v155
    v_cvt_pk_bf16_f32 v12, v44, v45
    v_cvt_pk_bf16_f32 v13, v46, v47
    v_mfma_f32_16x16x16_bf16 v[64:67], v[114:115], v[74:75], 0
    v_cvt_pk_bf16_f32 v14, v48, v49
    v_cvt_pk_bf16_f32 v15, v50, v51
    v_mfma_f32_16x16x16_bf16 v[56:59], v[112:113], v[74:75], 0
    buffer_store_dwordx4 v[12:15], v225, s[48:51], s14 offen sc1
    v_cvt_pk_bf16_f32 v8, v36, v37
    v_cvt_pk_bf16_f32 v9, v38, v39
    v_cvt_pk_bf16_f32 v10, v40, v41
    v_cvt_pk_bf16_f32 v11, v42, v43
    buffer_store_dwordx4 v[8:11], v225, s[48:51], s15 offen sc1
    v_cvt_pk_bf16_f32 v20, v60, v61
    v_cvt_pk_bf16_f32 v21, v62, v63
    v_cvt_pk_bf16_f32 v22, v64, v65
    v_cvt_pk_bf16_f32 v23, v66, v67
    buffer_store_dwordx4 v[20:23], v225, s[48:51], s14 offen offset:1024 sc1
    v_cvt_pk_bf16_f32 v16, v52, v53
    v_cvt_pk_bf16_f32 v17, v54, v55
    v_cvt_pk_bf16_f32 v18, v56, v57
    v_cvt_pk_bf16_f32 v19, v58, v59
    buffer_store_dwordx4 v[16:19], v225, s[48:51], s15 offen offset:1024 sc1
    s_lshr_b32 s77, s92, 1
    s_xor_b32 m0, s75, 98304
    s_xor_b32 s87, s33, 512
    buffer_load_dwordx4 v219, s[56:59], s87 offen lds
    s_lshr_b32 s79, s74, 1
    s_lshl1_add_u32 s80, s79, s77
    v_bfe_u32 v229, v0, 0, 3
    v_lshlrev_b32 v229, 7, v229
    v_lshl_add_u32 v229, s80, 10, v229
    s_mov_b32 s28, 131072
    s_mov_b32 s29, 65536
    s_mul_i32 s80, s74, 98304
    s_lshl_b32 s30, s77, 14
    buffer_load_dwordx4 v218, s[56:59], s87 offen offset:2048 lds
    s_lshl1_add_u32 s31, s30, s80
    s_add_u32 s31, s31, 1064960
    s_add_u32 s30, s30, s80
    s_add_u32 s30, s30, 1114112
    s_lshl4_add_u32 s30, s33, s30
    s_mov_b32 s27, 0x10000
    s_mul_i32 s80, s77, 36864
    s_add_u32 s80, s80, 65536
    v_add_u32 v213, s80, v233
    v_xor_b32 v212, 64, v213
    s_xor_b32 m0, s75, 106496
    s_xor_b32 s87, s33, 640
    buffer_load_dwordx4 v219, s[56:59], s87 offen lds
    v_xor_b32 v211, 4096, v213
    v_xor_b32 v210, 4096, v212
    v_bfe_u32 v255, v0, 4, 2
    v_lshlrev_b32 v255, 5, v255
    v_xor_b32 v255, v255, v252
    v_lshl_add_u32 v228, s92, 12, v255
    v_add_u32 v228, 65536, v228
    v_and_b32 v255, 0x8, v0
    v_bfe_u32 v254, v0, 4, 1
    buffer_load_dwordx4 v218, s[56:59], s87 offen offset:2048 lds
    v_lshl_or_b32 v255, v254, 0, v255
    v_bfe_u32 v254, v0, 5, 1
    v_lshl_or_b32 v255, v254, 4, v255
    v_bfe_u32 v254, v0, 6, 1
    v_lshl_or_b32 v255, v254, 2, v255
    v_lshl_add_u32 v255, s79, 6, v255
L_pg1825:
    s_cbranch_execz L_backs
    v_bfe_u32 v254, v0, 0, 3
    v_lshlrev_b32 v254, 4, v254
    v_lshl_add_u32 v255, v255, 11, v254
    s_lshl1_add_u32 s80, s91, s77
    s_xor_b32 m0, s75, 114688
    s_xor_b32 s87, s33, 768
    buffer_load_dwordx4 v219, s[56:59], s87 offen lds
    v_lshl_add_u32 v227, s80, 7, v255
    v_sub_f32 v108, 1.0, v24
    v_sub_f32 v109, 1.0, v26
    v_and_b32 v100, 0xffff, v2
    v_and_b32 v101, 0xffff0000, v2
    v_and_b32 v102, 0xffff, v3
    v_and_b32 v103, 0xffff0000, v3
    v_and_b32 v104, 0xffff, v4
    v_and_b32 v105, 0xffff0000, v4
    buffer_load_dwordx4 v218, s[56:59], s87 offen offset:2048 lds
    v_and_b32 v106, 0xffff, v5
    v_and_b32 v107, 0xffff0000, v5
    v_cvt_pk_bf16_f32 v108, 0, v108
    v_cvt_pk_bf16_f32 v109, 0, v109
    v_dot2_f32_bf16 v8, v28, v100, 0
    v_dot2_f32_bf16 v9, v28, v101, 0
    v_dot2_f32_bf16 v10, v29, v102, 0
    v_dot2_f32_bf16 v11, v29, v103, 0
    v_dot2_f32_bf16 v12, v30, v104, 0
    v_dot2_f32_bf16 v13, v30, v105, 0
    s_xor_b32 m0, s75, 122880
    s_xor_b32 s87, s33, 896
    buffer_load_dwordx4 v219, s[56:59], s87 offen lds
    v_dot2_f32_bf16 v14, v31, v106, 0
    v_dot2_f32_bf16 v15, v31, v107, 0
    v_dot2_f32_bf16 v16, v32, v100, 0
    v_dot2_f32_bf16 v17, v32, v101, 0
    v_dot2_f32_bf16 v18, v33, v102, 0
    v_dot2_f32_bf16 v19, v33, v103, 0
    v_dot2_f32_bf16 v20, v34, v104, 0
    v_dot2_f32_bf16 v21, v34, v105, 0
    v_dot2_f32_bf16 v22, v35, v106, 0
    buffer_load_dwordx4 v218, s[56:59], s87 offen offset:2048 lds
    v_dot2_f32_bf16 v23, v35, v107, 0
    v_pk_mul_f32 v[8:9], v[108:109], v[8:9] op_sel_hi:[0,1]
    v_pk_mul_f32 v[10:11], v[108:109], v[10:11] op_sel_hi:[0,1]
    v_pk_mul_f32 v[12:13], v[108:109], v[12:13] op_sel_hi:[0,1]
    v_pk_mul_f32 v[14:15], v[108:109], v[14:15] op_sel_hi:[0,1]
    v_pk_mul_f32 v[16:17], v[108:109], v[16:17] op_sel:[1,0]
    v_pk_mul_f32 v[18:19], v[108:109], v[18:19] op_sel:[1,0]
    v_pk_mul_f32 v[20:21], v[108:109], v[20:21] op_sel:[1,0]
    v_pk_mul_f32 v[22:23], v[108:109], v[22:23] op_sel:[1,0]
    s_waitcnt vmcnt(8)
    buffer_store_dword v240, v232, s[48:51], 0 offen sc1
    s_waitcnt vmcnt(1)
    s_barrier
    s_add_u32 m0, s76, 131072
    s_xor_b32 s87, s32, 131072
    buffer_load_dwordx4 v223, s[60:63], s87 offen lds
    buffer_load_dwordx4 v222, s[60:63], s87 offen offset:1024 lds
    buffer_load_dwordx4 v221, s[60:63], s87 offen offset:2048 lds
    buffer_load_dwordx4 v220, s[60:63], s87 offen offset:3072 lds
    s_add_u32 m0, s76, 135168
    s_xor_b32 s87, s32, 163840
    buffer_load_dwordx4 v223, s[60:63], s87 offen lds
    buffer_load_dwordx4 v222, s[60:63], s87 offen offset:1024 lds
    buffer_load_dwordx4 v221, s[60:63], s87 offen offset:2048 lds
    buffer_load_dwordx4 v220, s[60:63], s87 offen offset:3072 lds
    ds_read_b128 v[68:71], v213 offset:0
    ds_read_b128 v[72:75], v213 offset:2048
    ds_read_b128 v[76:79], v211 offset:0
    ds_read_b128 v[80:83], v211 offset:2048
    ds_read_b128 v[84:87], v212 offset:0
    ds_read_b128 v[88:91], v212 offset:2048
    s_waitcnt vmcnt(8)
    buffer_load_dword v253, v229, s[48:51], s29 offen sc1
    s_waitcnt vmcnt(0)
    s_branch L_hchks
L_hpolls:
    buffer_load_dword v253, v229, s[48:51], s29 offen sc1
    s_waitcnt vmcnt(0)
L_hchks:
    v_cmp_ne_u32 vcc, s85, v253
    s_sub_u32 s72, s72, 1
    s_cselect_b64 vcc, 0, vcc
    s_cselect_b32 s72, 0, s72
    s_cmp_lg_u64 vcc, 0
    s_cbranch_scc1 L_hpolls
    s_xor_b32 s80, s31, 0
    buffer_load_dwordx4 a[128:131], v225, s[48:51], s80 offen sc1
    buffer_load_dwordx4 a[132:135], v225, s[48:51], s80 offen offset:1024 sc1
    buffer_load_dwordx4 a[136:139], v225, s[48:51], s80 offen offset:2048 sc1
    buffer_load_dwordx4 a[140:143], v225, s[48:51], s80 offen offset:3072 sc1
    s_xor_b32 s80, s31, 4096
    buffer_load_dwordx4 a[144:147], v225, s[48:51], s80 offen sc1
    buffer_load_dwordx4 a[148:151], v225, s[48:51], s80 offen offset:1024 sc1
    buffer_load_dwordx4 a[152:155], v225, s[48:51], s80 offen offset:2048 sc1
    buffer_load_dwordx4 a[156:159], v225, s[48:51], s80 offen offset:3072 sc1
    s_xor_b32 s80, s31, 8192
    buffer_load_dwordx4 a[160:163], v225, s[48:51], s80 offen sc1
    buffer_load_dwordx4 a[164:167], v225, s[48:51], s80 offen offset:1024 sc1
    s_waitcnt vmcnt(8) lgkmcnt(4)
    v_mfma_f32_16x16x32_bf16 v[36:39], v[68:71], a[128:131], v[8:11]
    s_xor_b32 m0, s75, 32768
    s_xor_b32 s87, s33, 512
    buffer_load_dwordx4 v219, s[52:55], s87 offen lds
    v_mfma_f32_16x16x32_bf16 v[44:47], v[68:71], a[132:135], v[16:19]
    ds_read_b128 v[92:95], v210 offset:0
    v_mfma_f32_16x16x32_bf16 v[40:43], v[72:75], a[128:131], v[12:15]
    buffer_load_dwordx4 v218, s[52:55], s87 offen offset:2048 lds
    v_mfma_f32_16x16x32_bf16 v[48:51], v[72:75], a[132:135], v[20:23]
    ds_read_b128 v[96:99], v210 offset:2048
    s_waitcnt lgkmcnt(4)
    v_mfma_f32_16x16x32_bf16 v[52:55], v[76:79], a[128:131], 0
    s_xor_b32 m0, s75, 40960
    s_xor_b32 s87, s33, 640
    buffer_load_dwordx4 v219, s[52:55], s87 offen lds
    v_mfma_f32_16x16x32_bf16 v[60:63], v[76:79], a[132:135], 0
    ds_read_b128 v[68:71], v213 offset:8192
    v_mfma_f32_16x16x32_bf16 v[56:59], v[80:83], a[128:131], 0
    buffer_load_dwordx4 v218, s[52:55], s87 offen offset:2048 lds
    v_mfma_f32_16x16x32_bf16 v[64:67], v[80:83], a[132:135], 0
    ds_read_b128 v[72:75], v213 offset:10240
    s_waitcnt vmcnt(10) lgkmcnt(4)
    v_mfma_f32_16x16x32_bf16 v[36:39], v[84:87], a[136:139], v[36:39]
    s_xor_b32 m0, s75, 49152
    s_xor_b32 s87, s33, 768
    buffer_load_dwordx4 v219, s[52:55], s87 offen lds
    v_mfma_f32_16x16x32_bf16 v[44:47], v[84:87], a[140:143], v[44:47]
    ds_read_b128 v[76:79], v211 offset:8192
    v_mfma_f32_16x16x32_bf16 v[40:43], v[88:91], a[136:139], v[40:43]
    buffer_load_dwordx4 v218, s[52:55], s87 offen offset:2048 lds
    v_mfma_f32_16x16x32_bf16 v[48:51], v[88:91], a[140:143], v[48:51]
    ds_read_b128 v[80:83], v211 offset:10240
    s_waitcnt lgkmcnt(4)
    v_mfma_f32_16x16x32_bf16 v[52:55], v[92:95], a[136:139], v[52:55]
    s_xor_b32 m0, s75, 57344
    s_xor_b32 s87, s33, 896
    buffer_load_dwordx4 v219, s[52:55], s87 offen lds
    v_mfma_f32_16x16x32_bf16 v[60:63], v[92:95], a[140:143], v[60:63]
    ds_read_b128 v[84:87], v212 offset:8192
    v_mfma_f32_16x16x32_bf16 v[56:59], v[96:99], a[136:139], v[56:59]
    v_mfma_f32_16x16x32_bf16 v[64:67], v[96:99], a[140:143], v[64:67]
    ds_read_b128 v[88:91], v212 offset:10240
    s_waitcnt vmcnt(11) lgkmcnt(4)
    v_mfma_f32_16x16x32_bf16 v[36:39], v[68:71], a[144:147], v[36:39]
    buffer_load_dwordx4 v218, s[52:55], s87 offen offset:2048 lds
    v_mfma_f32_16x16x32_bf16 v[44:47], v[68:71], a[148:151], v[44:47]
    ds_read_b128 v[92:95], v210 offset:8192
    v_mfma_f32_16x16x32_bf16 v[40:43], v[72:75], a[144:147], v[40:43]
    buffer_load_dwordx4 a[168:171], v225, s[48:51], s80 offen offset:2048 sc1
    v_mfma_f32_16x16x32_bf16 v[48:51], v[72:75], a[148:151], v[48:51]
    ds_read_b128 v[96:99], v210 offset:10240
    s_waitcnt lgkmcnt(4)
    v_mfma_f32_16x16x32_bf16 v[52:55], v[76:79], a[144:147], v[52:55]
    buffer_load_dwordx4 a[172:175], v225, s[48:51], s80 offen offset:3072 sc1
    v_mfma_f32_16x16x32_bf16 v[60:63], v[76:79], a[148:151], v[60:63]
    ds_read_b128 v[68:71], v213 offset:16384
    v_mfma_f32_16x16x32_bf16 v[56:59], v[80:83], a[144:147], v[56:59]
    v_mfma_f32_16x16x32_bf16 v[64:67], v[80:83], a[148:151], v[64:67]
    ds_read_b128 v[72:75], v213 offset:18432
    s_waitcnt vmcnt(12) lgkmcnt(4)
    v_mfma_f32_16x16x32_bf16 v[36:39], v[84:87], a[152:155], v[36:39]
    s_xor_b32 s80, s31, 12288
    buffer_load_dwordx4 a[176:179], v225, s[48:51], s80 offen sc1
    v_mfma_f32_16x16x32_bf16 v[44:47], v[84:87], a[156:159], v[44:47]
    ds_read_b128 v[76:79], v211 offset:16384
    v_mfma_f32_16x16x32_bf16 v[40:43], v[88:91], a[152:155], v[40:43]
    buffer_load_dwordx4 a[180:183], v225, s[48:51], s80 offen offset:1024 sc1
    v_mfma_f32_16x16x32_bf16 v[48:51], v[88:91], a[156:159], v[48:51]
    ds_read_b128 v[80:83], v211 offset:18432
    s_waitcnt lgkmcnt(4)
    v_mfma_f32_16x16x32_bf16 v[52:55], v[92:95], a[152:155], v[52:55]
    buffer_load_dwordx4 a[184:187], v225, s[48:51], s80 offen offset:2048 sc1
    v_mfma_f32_16x16x32_bf16 v[60:63], v[92:95], a[156:159], v[60:63]
    ds_read_b128 v[84:87], v212 offset:16384
    v_mfma_f32_16x16x32_bf16 v[56:59], v[96:99], a[152:155], v[56:59]
    buffer_load_dwordx4 a[188:191], v225, s[48:51], s80 offen offset:3072 sc1
    v_mfma_f32_16x16x32_bf16 v[64:67], v[96:99], a[156:159], v[64:67]
    ds_read_b128 v[88:91], v212 offset:18432
    s_waitcnt vmcnt(14) lgkmcnt(4)
    v_mfma_f32_16x16x32_bf16 v[36:39], v[68:71], a[160:163], v[36:39]
    s_xor_b32 s80, s31, 16384
    buffer_load_dwordx4 a[192:195], v225, s[48:51], s80 offen sc1
    v_mfma_f32_16x16x32_bf16 v[44:47], v[68:71], a[164:167], v[44:47]
    ds_read_b128 v[92:95], v210 offset:16384
    v_mfma_f32_16x16x32_bf16 v[40:43], v[72:75], a[160:163], v[40:43]
    buffer_load_dwordx4 a[196:199], v225, s[48:51], s80 offen offset:1024 sc1
    v_mfma_f32_16x16x32_bf16 v[48:51], v[72:75], a[164:167], v[48:51]
    ds_read_b128 v[96:99], v210 offset:18432
    s_waitcnt lgkmcnt(4)
    v_mfma_f32_16x16x32_bf16 v[52:55], v[76:79], a[160:163], v[52:55]
    buffer_load_dwordx4 a[200:203], v225, s[48:51], s80 offen offset:2048 sc1
    v_mfma_f32_16x16x32_bf16 v[60:63], v[76:79], a[164:167], v[60:63]
    ds_read_b128 v[68:71], v213 offset:24576
    v_mfma_f32_16x16x32_bf16 v[56:59], v[80:83], a[160:163], v[56:59]
    v_mfma_f32_16x16x32_bf16 v[64:67], v[80:83], a[164:167], v[64:67]
    ds_read_b128 v[72:75], v213 offset:26624
    s_waitcnt vmcnt(7) lgkmcnt(4)
    v_mfma_f32_16x16x32_bf16 v[36:39], v[84:87], a[168:171], v[36:39]
    buffer_load_dwordx4 a[204:207], v225, s[48:51], s80 offen offset:3072 sc1
    v_mfma_f32_16x16x32_bf16 v[44:47], v[84:87], a[172:175], v[44:47]
    ds_read_b128 v[76:79], v211 offset:24576
    v_mfma_f32_16x16x32_bf16 v[40:43], v[88:91], a[168:171], v[40:43]
    s_xor_b32 s80, s31, 20480
    buffer_load_dwordx4 a[208:211], v225, s[48:51], s80 offen sc1
    v_mfma_f32_16x16x32_bf16 v[48:51], v[88:91], a[172:175], v[48:51]
    ds_read_b128 v[80:83], v211 offset:26624
    s_waitcnt lgkmcnt(4)
    v_mfma_f32_16x16x32_bf16 v[52:55], v[92:95], a[168:171], v[52:55]
    buffer_load_dwordx4 a[212:215], v225, s[48:51], s80 offen offset:1024 sc1
    v_mfma_f32_16x16x32_bf16 v[60:63], v[92:95], a[172:175], v[60:63]
    ds_read_b128 v[84:87], v212 offset:24576
    v_mfma_f32_16x16x32_bf16 v[56:59], v[96:99], a[168:171], v[56:59]
    v_mfma_f32_16x16x32_bf16 v[64:67], v[96:99], a[172:175], v[64:67]
    ds_read_b128 v[88:91], v212 offset:26624
    s_branch L_p2
L_att:
    v_lshl_add_u32 v251, s92, 12, v233
    v_xor_b32 v250, 64, v251
    v_xor_b32 v238, 4096, v251
    v_xor_b32 v237, 4096, v250
    v_add_u32 v248, 0x10000, v251
    v_add_u32 v239, 0x10000, v250
    v_add_u32 v236, 0x10000, v238
    v_add_u32 v235, 0x10000, v237
    v_and_b32 v255, 64, v0
    v_xor_b32 v234, v255, v224
    v_xor_b32 v204, 32, v234
    v_add_u32 v203, 0x10000, v234
    v_add_u32 v202, 0x10000, v204
    global_load_dword v253, v226, s[48:49]
    s_add_u32 m0, s89, 114688
    s_mul_i32 s86, s88, s83
    buffer_load_dwordx4 v244, s[40:43], s86 offen lds
    buffer_load_dwordx4 v243, s[40:43], s86 offen offset:2048 lds
    s_add_u32 m0, s89, 118784
    s_lshl_b32 s87, s88, 7
    buffer_load_dwordx4 v242, s[44:47], s86 offen lds
    buffer_load_dwordx4 v241, s[44:47], s86 offen offset:2048 lds
    s_mov_b64 exec, 0
    s_cmp_eq_u32 s92, 0
    s_cbranch_scc1 L_pg2422
    s_cmp_eq_u32 s92, 1
    s_cbranch_scc1 L_pg3011
    s_cmp_eq_u32 s92, 2
    s_cbranch_scc1 L_pg3574
    s_branch L_pg4212
L_backa:
    s_mov_b64 exec, -1
    s_add_u32 m0, s89, 98304
    s_add_u32 s88, s88, 1
    buffer_load_dwordx4 v246, s[36:39], s87 offen lds
    buffer_load_dwordx4 v246, s[36:39], s87 offen offset:2048 lds
    s_add_u32 m0, s89, 102400
    s_and_b32 s88, s88, 7
    buffer_load_dwordx4 v245, s[36:39], s87 offen lds
    buffer_load_dwordx4 v245, s[36:39], s87 offen offset:2048 lds
    s_branch L_loopa
L_xd_a0:
    ds_read_b64 v[28:29], v207 offset:0
    ds_read_b64 v[30:31], v206 offset:0
    ds_read_b64 v[32:33], v207 offset:2048
    ds_read_b64 v[34:35], v206 offset:2048
    s_branch L_nx_a0
L_xd_a1:
    ds_read_b64 v[28:29], v207 offset:32768
    ds_read_b64 v[30:31], v206 offset:32768
    ds_read_b64 v[32:33], v207 offset:34816
    ds_read_b64 v[34:35], v206 offset:34816
    s_branch L_nx_a1
L_xd_a2:
    ds_read_b64 v[28:29], v209 offset:0
    ds_read_b64 v[30:31], v208 offset:0
    ds_read_b64 v[32:33], v209 offset:2048
    ds_read_b64 v[34:35], v208 offset:2048
    s_branch L_nx_a2
L_xd_a3:
    ds_read_b64 v[28:29], v209 offset:32768
    ds_read_b64 v[30:31], v208 offset:32768
    ds_read_b64 v[32:33], v209 offset:34816
    ds_read_b64 v[34:35], v208 offset:34816
    s_branch L_nx_a3
L_xd_a4:
    ds_read_b64 v[28:29], v207 offset:0
    ds_read_b64 v[30:31], v206 offset:0
    ds_read_b64 v[32:33], v207 offset:2048
    ds_read_b64 v[34:35], v206 offset:2048
    s_branch L_nx_a4
L_xd_a5:
    ds_read_b64 v[28:29], v207 offset:32768
    ds_read_b64 v[30:31], v206 offset:32768
    ds_read_b64 v[32:33], v207 offset:34816
    ds_read_b64 v[34:35], v206 offset:34816
    s_branch L_nx_a5
L_xd_a6:
    ds_read_b64 v[28:29], v209 offset:0
    ds_read_b64 v[30:31], v208 offset:0
    ds_read_b64 v[32:33], v209 offset:2048
    ds_read_b64 v[34:35], v208 offset:2048
    s_branch L_nx_a6
L_xd_a7:
    ds_read_b64 v[28:29], v209 offset:32768
    ds_read_b64 v[30:31], v208 offset:32768
    ds_read_b64 v[32:33], v209 offset:34816
    ds_read_b64 v[34:35], v208 offset:34816
    s_branch L_nx_a7
L_loopa:
    s_waitcnt vmcnt(9) lgkmcnt(0)
    s_barrier
    ds_read_b64_tr_b16 a[80:81], v203 offset:16384
    ds_read_b64_tr_b16 a[82:83], v203 offset:18432
    ds_read_b128 a[128:131], v248 offset:0
    ds_read_b128 a[132:135], v248 offset:2048
    ds_read_b128 a[72:75], v236 offset:0
    ds_read_b128 a[76:79], v236 offset:2048
    ds_read_b64_tr_b16 a[84:85], v202 offset:16384
    ds_read_b64_tr_b16 a[86:87], v202 offset:18432
    s_add_u32 s84, s84, 1
    s_mul_i32 s85, s84, 0x9e3779b1
    v_mov_b32 v240, s85
    s_waitcnt lgkmcnt(4)
    v_mfma_f32_16x16x32_bf16 v[76:79], a[128:131], a[80:83], 0
    v_mov_b32 v20, 0
    v_mov_b32 v22, 0
    v_dot2c_f32_bf16 v20, v8, v16
    v_mfma_f32_16x16x32_bf16 v[80:83], a[132:135], a[80:83], 0
    ds_read_b64_tr_b16 a[88:89], v203 offset:24576
    v_dot2c_f32_bf16 v22, v12, v16
    v_dot2c_f32_bf16 v20, v9, v17
    v_dot2c_f32_bf16 v22, v13, v17
    s_waitcnt lgkmcnt(3)
    v_mfma_f32_16x16x32_bf16 v[84:87], a[72:75], a[80:83], 0
    ds_read_b64_tr_b16 a[90:91], v203 offset:26624
    v_dot2c_f32_bf16 v20, v10, v18
    v_dot2c_f32_bf16 v22, v14, v18
    v_dot2c_f32_bf16 v20, v11, v19
    v_mfma_f32_16x16x32_bf16 v[88:91], a[76:79], a[80:83], 0
    v_dot2c_f32_bf16 v22, v15, v19
    v_mov_b32 v21, v240
    v_mov_b32 v23, v240
    s_waitcnt lgkmcnt(2)
    v_mfma_f32_16x16x32_bf16 v[92:95], a[128:131], a[84:87], 0
    s_cmp_eq_u32 s81, 0
    s_cbranch_scc1 L_xd_a0
L_nx_a0:
    s_add_u32 m0, s89, 16384
    v_cmp_eq_u32 vcc, 0x3f0, v252
    v_add_f32_dpp v20, v20, v20 row_shr:1 row_mask:0xf bank_mask:0xf
    v_add_f32_dpp v22, v22, v22 row_shr:1 row_mask:0xf bank_mask:0xf
    v_mfma_f32_16x16x32_bf16 v[96:99], a[132:135], a[84:87], 0
    ds_read_b64_tr_b16 a[92:93], v202 offset:24576
    s_mul_i32 s86, s88, s83
    v_mov_b32 v182, 0x20000000
    s_and_b32 s15, s82, 32
    v_add_f32_dpp v20, v20, v20 row_shr:2 row_mask:0xf bank_mask:0xf
    v_mfma_f32_16x16x32_bf16 v[100:103], a[72:75], a[84:87], 0
    ds_read_b64_tr_b16 a[94:95], v202 offset:26624
    buffer_load_dwordx4 v244, s[40:43], s86 offen lds
    v_add_f32_dpp v22, v22, v22 row_shr:2 row_mask:0xf bank_mask:0xf
    s_bfe_u32 s14, s82, 0x10001
    v_mfma_f32_16x16x32_bf16 v[104:107], a[76:79], a[84:87], 0
    s_lshl4_add_u32 s15, s14, s15
    v_add_f32_dpp v20, v20, v20 row_shr:4 row_mask:0xf bank_mask:0xf
    s_waitcnt lgkmcnt(2)
    v_mfma_f32_16x16x32_bf16 v[108:111], a[128:131], a[88:91], 0
    ds_read_b64_tr_b16 a[112:113], v203 offset:20480
    buffer_load_dwordx4 v243, s[40:43], s86 offen offset:2048 lds
    s_add_u32 m0, s89, 20480
    v_add_f32_dpp v22, v22, v22 row_shr:4 row_mask:0xf bank_mask:0xf
    s_bfe_u32 s14, s82, 0x20003
    v_mfma_f32_16x16x32_bf16 v[112:115], a[132:135], a[88:91], 0
    ds_read_b64_tr_b16 a[114:115], v203 offset:22528
    s_lshl_b32 s87, s88, 7
    s_lshl2_add_u32 s15, s14, s15
    v_add_f32_dpp v20, v20, v20 row_shr:8 row_mask:0xf bank_mask:0xf
    v_mfma_f32_16x16x32_bf16 v[116:119], a[72:75], a[88:91], 0
    ds_read_b128 a[136:139], v239 offset:0
    buffer_load_dwordx4 v242, s[44:47], s86 offen lds
    v_add_f32_dpp v22, v22, v22 row_shr:8 row_mask:0xf bank_mask:0xf
    s_bfe_u32 s14, s82, 0x10000
    v_mfma_f32_16x16x32_bf16 v[120:123], a[76:79], a[88:91], 0
    ds_read_b128 a[140:143], v239 offset:2048
    s_lshl1_add_u32 s15, s14, s15
    v_add_f32_dpp v20, v20, v20 row_bcast:15 row_mask:0xa bank_mask:0xf
    s_waitcnt lgkmcnt(4)
    v_mfma_f32_16x16x32_bf16 v[124:127], a[128:131], a[92:95], 0
    ds_read_b128 a[104:107], v235 offset:0
    buffer_load_dwordx4 v241, s[44:47], s86 offen offset:2048 lds
    s_add_u32 m0, s89, 0
    v_add_f32_dpp v22, v22, v22 row_bcast:15 row_mask:0xa bank_mask:0xf
    s_bfe_u32 s14, s82, 0x10002
    v_mfma_f32_16x16x32_bf16 v[128:131], a[132:135], a[92:95], 0
    ds_read_b128 a[108:111], v235 offset:2048
    s_add_u32 s88, s88, 1
    s_add_u32 s15, s14, s15
    v_add_f32_dpp v20, v20, v20 row_bcast:31 row_mask:0xc bank_mask:0xf
    v_mfma_f32_16x16x32_bf16 v[132:135], a[72:75], a[92:95], 0
    ds_read_b64_tr_b16 a[116:117], v202 offset:20480
    buffer_load_dwordx4 v246, s[36:39], s87 offen lds
    v_add_f32_dpp v22, v22, v22 row_bcast:31 row_mask:0xc bank_mask:0xf
    v_cndmask_b32 v182, v182, 0, vcc
    v_mfma_f32_16x16x32_bf16 v[136:139], a[76:79], a[92:95], 0
    ds_read_b64_tr_b16 a[118:119], v202 offset:22528
    s_lshl_b32 s14, s95, 10
    v_mul_f32 v20, 0xbfb8aa3b, v20
    s_waitcnt lgkmcnt(4)
    v_mfma_f32_16x16x32_bf16 v[76:79], a[136:139], a[112:115], v[76:79]
    buffer_load_dwordx4 v246, s[36:39], s87 offen offset:2048 lds
    s_add_u32 m0, s89, 4096
    v_mul_f32 v22, 0xbfb8aa3b, v22
    v_exp_f32 v20, v20
    v_mfma_f32_16x16x32_bf16 v[80:83], a[140:143], a[112:115], v[80:83]
    ds_read_b64_tr_b16 a[120:121], v203 offset:28672
    s_and_b32 s88, s88, 7
    v_exp_f32 v22, v22
    v_add_f32 v20, 1.0, v20
    s_waitcnt lgkmcnt(3)
    v_mfma_f32_16x16x32_bf16 v[84:87], a[104:107], a[112:115], v[84:87]
    ds_read_b64_tr_b16 a[122:123], v203 offset:30720
    buffer_load_dwordx4 v245, s[36:39], s87 offen lds
    v_add_f32 v22, 1.0, v22
    v_rcp_f32 v20, v20
    v_mfma_f32_16x16x32_bf16 v[88:91], a[108:111], a[112:115], v[88:91]
    v_rcp_f32 v22, v22
    s_lshl4_add_u32 s15, s15, s14
    s_waitcnt lgkmcnt(2)
    v_mfma_f32_16x16x32_bf16 v[92:95], a[136:139], a[116:119], v[92:95]
    buffer_load_dwordx4 v245, s[36:39], s87 offen offset:2048 lds
    s_add_u32 s15, s15, 4096
    v_cvt_pk_bf16_f32 v20, 0, v20
    v_mfma_f32_16x16x32_bf16 v[96:99], a[140:143], a[116:119], v[96:99]
    ds_read_b64_tr_b16 a[124:125], v202 offset:28672
    v_cvt_pk_bf16_f32 v22, 0, v22
    buffer_store_dwordx4 v[20:23], v182, s[48:51], s15 offen sc1
    v_mfma_f32_16x16x32_bf16 v[100:103], a[104:107], a[116:119], v[100:103]
    ds_read_b64_tr_b16 a[126:127], v202 offset:30720
    v_mfma_f32_16x16x32_bf16 v[104:107], a[108:111], a[116:119], v[104:107]
    s_waitcnt vmcnt(9)
    s_barrier
    s_waitcnt lgkmcnt(2)
    v_mfma_f32_16x16x32_bf16 v[108:111], a[136:139], a[120:123], v[108:111]
    ds_read_b64_tr_b16 a[80:81], v203 offset:49152
    s_add_u32 m0, s89, 49152
    v_mfma_f32_16x16x32_bf16 v[112:115], a[140:143], a[120:123], v[112:115]
    ds_read_b64_tr_b16 a[82:83], v203 offset:51200
    s_mul_i32 s86, s88, s83
    v_mfma_f32_16x16x32_bf16 v[116:119], a[104:107], a[120:123], v[116:119]
    ds_read_b128 a[144:147], v248 offset:32768
    buffer_load_dwordx4 v244, s[40:43], s86 offen lds
    v_mfma_f32_16x16x32_bf16 v[120:123], a[108:111], a[120:123], v[120:123]
    ds_read_b128 a[148:151], v248 offset:34816
    s_waitcnt lgkmcnt(4)
    v_mfma_f32_16x16x32_bf16 v[124:127], a[136:139], a[124:127], v[124:127]
    ds_read_b128 a[72:75], v236 offset:32768
    v_mfma_f32_16x16x32_bf16 v[128:131], a[140:143], a[124:127], v[128:131]
    ds_read_b128 a[76:79], v236 offset:34816
    v_mfma_f32_16x16x32_bf16 v[132:135], a[104:107], a[124:127], v[132:135]
    ds_read_b64_tr_b16 a[84:85], v202 offset:49152
    buffer_load_dwordx4 v243, s[40:43], s86 offen offset:2048 lds
    v_mfma_f32_16x16x32_bf16 v[136:139], a[108:111], a[124:127], v[136:139]
    ds_read_b64_tr_b16 a[86:87], v202 offset:51200
    s_waitcnt lgkmcnt(4)
    v_mfma_f32_16x16x32_bf16 v[76:79], a[144:147], a[80:83], v[76:79]
    s_add_u32 m0, s89, 53248
    v_mfma_f32_16x16x32_bf16 v[80:83], a[148:151], a[80:83], v[80:83]
    ds_read_b64_tr_b16 a[88:89], v203 offset:57344
    s_lshl_b32 s87, s88, 7
    s_waitcnt lgkmcnt(3)
    v_mfma_f32_16x16x32_bf16 v[84:87], a[72:75], a[80:83], v[84:87]
    ds_read_b64_tr_b16 a[90:91], v203 offset:59392
    buffer_load_dwordx4 v242, s[44:47], s86 offen lds
    v_mfma_f32_16x16x32_bf16 v[88:91], a[76:79], a[80:83], v[88:91]
    s_waitcnt lgkmcnt(2)
    v_mfma_f32_16x16x32_bf16 v[92:95], a[144:147], a[84:87], v[92:95]
    s_cmp_eq_u32 s81, 1
    s_cbranch_scc1 L_xd_a1
L_nx_a1:
    v_mfma_f32_16x16x32_bf16 v[96:99], a[148:151], a[84:87], v[96:99]
    ds_read_b64_tr_b16 a[92:93], v202 offset:57344
    v_mfma_f32_16x16x32_bf16 v[100:103], a[72:75], a[84:87], v[100:103]
    ds_read_b64_tr_b16 a[94:95], v202 offset:59392
    buffer_load_dwordx4 v241, s[44:47], s86 offen offset:2048 lds
    v_mfma_f32_16x16x32_bf16 v[104:107], a[76:79], a[84:87], v[104:107]
    s_waitcnt lgkmcnt(2)
    v_mfma_f32_16x16x32_bf16 v[108:111], a[144:147], a[88:91], v[108:111]
    ds_read_b64_tr_b16 a[112:113], v203 offset:53248
    s_add_u32 m0, s89, 32768
    v_mfma_f32_16x16x32_bf16 v[112:115], a[148:151], a[88:91], v[112:115]
    ds_read_b64_tr_b16 a[114:115], v203 offset:55296
    s_add_u32 s88, s88, 1
    v_mfma_f32_16x16x32_bf16 v[116:119], a[72:75], a[88:91], v[116:119]
    ds_read_b128 a[152:155], v239 offset:32768
    buffer_load_dwordx4 v246, s[36:39], s87 offen lds
    v_mfma_f32_16x16x32_bf16 v[120:123], a[76:79], a[88:91], v[120:123]
    ds_read_b128 a[156:159], v239 offset:34816
    s_waitcnt lgkmcnt(4)
    v_mfma_f32_16x16x32_bf16 v[124:127], a[144:147], a[92:95], v[124:127]
    ds_read_b128 a[104:107], v235 offset:32768
    v_mfma_f32_16x16x32_bf16 v[128:131], a[148:151], a[92:95], v[128:131]
    ds_read_b128 a[108:111], v235 offset:34816
    v_mfma_f32_16x16x32_bf16 v[132:135], a[72:75], a[92:95], v[132:135]
    ds_read_b64_tr_b16 a[116:117], v202 offset:53248
    buffer_load_dwordx4 v246, s[36:39], s87 offen offset:2048 lds
    v_mfma_f32_16x16x32_bf16 v[136:139], a[76:79], a[92:95], v[136:139]
    ds_read_b64_tr_b16 a[118:119], v202 offset:55296
    s_waitcnt lgkmcnt(4)
    v_mfma_f32_16x16x32_bf16 v[76:79], a[152:155], a[112:115], v[76:79]
    s_add_u32 m0, s89, 36864
    v_mfma_f32_16x16x32_bf16 v[80:83], a[156:159], a[112:115], v[80:83]
    ds_read_b64_tr_b16 a[120:121], v203 offset:61440
    s_and_b32 s88, s88, 7
    s_waitcnt lgkmcnt(3)
    v_mfma_f32_16x16x32_bf16 v[84:87], a[104:107], a[112:115], v[84:87]
    ds_read_b64_tr_b16 a[122:123], v203 offset:63488
    buffer_load_dwordx4 v245, s[36:39], s87 offen lds
    v_mfma_f32_16x16x32_bf16 v[88:91], a[108:111], a[112:115], v[88:91]
    s_waitcnt lgkmcnt(2)
    v_mfma_f32_16x16x32_bf16 v[92:95], a[152:155], a[116:119], v[92:95]
    v_mfma_f32_16x16x32_bf16 v[96:99], a[156:159], a[116:119], v[96:99]
    ds_read_b64_tr_b16 a[124:125], v202 offset:61440
    v_mfma_f32_16x16x32_bf16 v[100:103], a[104:107], a[116:119], v[100:103]
    ds_read_b64_tr_b16 a[126:127], v202 offset:63488
    buffer_load_dwordx4 v245, s[36:39], s87 offen offset:2048 lds
    v_mfma_f32_16x16x32_bf16 v[104:107], a[108:111], a[116:119], v[104:107]
    s_waitcnt vmcnt(9)
    s_barrier
    s_waitcnt lgkmcnt(2)
    v_mfma_f32_16x16x32_bf16 v[108:111], a[152:155], a[120:123], v[108:111]
    ds_read_b64_tr_b16 a[80:81], v234 offset:16384
    s_add_u32 m0, s89, 81920
    v_mfma_f32_16x16x32_bf16 v[112:115], a[156:159], a[120:123], v[112:115]
    ds_read_b64_tr_b16 a[82:83], v234 offset:18432
    s_mul_i32 s86, s88, s83
    v_mfma_f32_16x16x32_bf16 v[116:119], a[104:107], a[120:123], v[116:119]
    ds_read_b128 a[160:163], v251 offset:0
    buffer_load_dwordx4 v244, s[40:43], s86 offen lds
    v_mfma_f32_16x16x32_bf16 v[120:123], a[108:111], a[120:123], v[120:123]
    ds_read_b128 a[164:167], v251 offset:2048
    s_waitcnt lgkmcnt(4)
    v_mfma_f32_16x16x32_bf16 v[124:127], a[152:155], a[124:127], v[124:127]
    ds_read_b128 a[72:75], v238 offset:0
    v_mfma_f32_16x16x32_bf16 v[128:131], a[156:159], a[124:127], v[128:131]
    ds_read_b128 a[76:79], v238 offset:2048
    v_mfma_f32_16x16x32_bf16 v[132:135], a[104:107], a[124:127], v[132:135]
    ds_read_b64_tr_b16 a[84:85], v204 offset:16384
    buffer_load_dwordx4 v243, s[40:43], s86 offen offset:2048 lds
    v_mfma_f32_16x16x32_bf16 v[136:139], a[108:111], a[124:127], v[136:139]
    ds_read_b64_tr_b16 a[86:87], v204 offset:18432
    s_waitcnt lgkmcnt(4)
    v_mfma_f32_16x16x32_bf16 v[76:79], a[160:163], a[80:83], v[76:79]
    s_add_u32 m0, s89, 86016
    v_mfma_f32_16x16x32_bf16 v[80:83], a[164:167], a[80:83], v[80:83]
    ds_read_b64_tr_b16 a[88:89], v234 offset:24576
    s_lshl_b32 s87, s88, 7
    s_waitcnt lgkmcnt(3)
    v_mfma_f32_16x16x32_bf16 v[84:87], a[72:75], a[80:83], v[84:87]
    ds_read_b64_tr_b16 a[90:91], v234 offset:26624
    buffer_load_dwordx4 v242, s[44:47], s86 offen lds
    v_mfma_f32_16x16x32_bf16 v[88:91], a[76:79], a[80:83], v[88:91]
    s_waitcnt lgkmcnt(2)
    v_mfma_f32_16x16x32_bf16 v[92:95], a[160:163], a[84:87], v[92:95]
    s_cmp_eq_u32 s81, 2
    s_cbranch_scc1 L_xd_a2
L_nx_a2:
    v_mfma_f32_16x16x32_bf16 v[96:99], a[164:167], a[84:87], v[96:99]
    ds_read_b64_tr_b16 a[92:93], v204 offset:24576
    v_mfma_f32_16x16x32_bf16 v[100:103], a[72:75], a[84:87], v[100:103]
    ds_read_b64_tr_b16 a[94:95], v204 offset:26624
    buffer_load_dwordx4 v241, s[44:47], s86 offen offset:2048 lds
    v_mfma_f32_16x16x32_bf16 v[104:107], a[76:79], a[84:87], v[104:107]
    s_waitcnt lgkmcnt(2)
    v_mfma_f32_16x16x32_bf16 v[108:111], a[160:163], a[88:91], v[108:111]
    ds_read_b64_tr_b16 a[112:113], v234 offset:20480
    s_add_u32 m0, s89, 65536
    v_mfma_f32_16x16x32_bf16 v[112:115], a[164:167], a[88:91], v[112:115]
    ds_read_b64_tr_b16 a[114:115], v234 offset:22528
    s_add_u32 s88, s88, 1
    v_mfma_f32_16x16x32_bf16 v[116:119], a[72:75], a[88:91], v[116:119]
    ds_read_b128 a[168:171], v250 offset:0
    buffer_load_dwordx4 v246, s[36:39], s87 offen lds
    v_mfma_f32_16x16x32_bf16 v[120:123], a[76:79], a[88:91], v[120:123]
    ds_read_b128 a[172:175], v250 offset:2048
    s_waitcnt lgkmcnt(4)
    v_mfma_f32_16x16x32_bf16 v[124:127], a[160:163], a[92:95], v[124:127]
    ds_read_b128 a[104:107], v237 offset:0
    v_mfma_f32_16x16x32_bf16 v[128:131], a[164:167], a[92:95], v[128:131]
    ds_read_b128 a[108:111], v237 offset:2048
    v_mfma_f32_16x16x32_bf16 v[132:135], a[72:75], a[92:95], v[132:135]
    ds_read_b64_tr_b16 a[116:117], v204 offset:20480
    buffer_load_dwordx4 v246, s[36:39], s87 offen offset:2048 lds
    v_mfma_f32_16x16x32_bf16 v[136:139], a[76:79], a[92:95], v[136:139]
    ds_read_b64_tr_b16 a[118:119], v204 offset:22528
    s_waitcnt lgkmcnt(4)
    v_mfma_f32_16x16x32_bf16 v[76:79], a[168:171], a[112:115], v[76:79]
    s_add_u32 m0, s89, 69632
    v_mfma_f32_16x16x32_bf16 v[80:83], a[172:175], a[112:115], v[80:83]
    ds_read_b64_tr_b16 a[120:121], v234 offset:28672
L_pg2422:
    s_cbranch_execz L_backa
    s_and_b32 s88, s88, 7
    s_waitcnt lgkmcnt(3)
    v_mfma_f32_16x16x32_bf16 v[84:87], a[104:107], a[112:115], v[84:87]
    ds_read_b64_tr_b16 a[122:123], v234 offset:30720
    buffer_load_dwordx4 v245, s[36:39], s87 offen lds
    v_mfma_f32_16x16x32_bf16 v[88:91], a[108:111], a[112:115], v[88:91]
    s_waitcnt lgkmcnt(2)
    v_mfma_f32_16x16x32_bf16 v[92:95], a[168:171], a[116:119], v[92:95]
    v_mfma_f32_16x16x32_bf16 v[96:99], a[172:175], a[116:119], v[96:99]
    ds_read_b64_tr_b16 a[124:125], v204 offset:28672
    v_mfma_f32_16x16x32_bf16 v[100:103], a[104:107], a[116:119], v[100:103]
    ds_read_b64_tr_b16 a[126:127], v204 offset:30720
    buffer_load_dwordx4 v245, s[36:39], s87 offen offset:2048 lds
    v_mfma_f32_16x16x32_bf16 v[104:107], a[108:111], a[116:119], v[104:107]
    s_waitcnt vmcnt(8)
    s_barrier
    s_waitcnt lgkmcnt(2)
    v_mfma_f32_16x16x32_bf16 v[108:111], a[168:171], a[120:123], v[108:111]
    ds_read_b64_tr_b16 a[80:81], v234 offset:49152
    s_add_u32 m0, s89, 114688
    global_load_dword v253, v205, s[6:7]
    v_mfma_f32_16x16x32_bf16 v[112:115], a[172:175], a[120:123], v[112:115]
    ds_read_b64_tr_b16 a[82:83], v234 offset:51200
    s_mul_i32 s86, s88, s83
    v_mfma_f32_16x16x32_bf16 v[116:119], a[104:107], a[120:123], v[116:119]
    ds_read_b128 a[176:179], v251 offset:32768
    buffer_load_dwordx4 v244, s[40:43], s86 offen lds
    v_mfma_f32_16x16x32_bf16 v[120:123], a[108:111], a[120:123], v[120:123]
    ds_read_b128 a[180:183], v251 offset:34816
    s_waitcnt lgkmcnt(4)
    v_mfma_f32_16x16x32_bf16 v[124:127], a[168:171], a[124:127], v[124:127]
    ds_read_b128 a[72:75], v238 offset:32768
    v_mfma_f32_16x16x32_bf16 v[128:131], a[172:175], a[124:127], v[128:131]
    ds_read_b128 a[76:79], v238 offset:34816
    v_mfma_f32_16x16x32_bf16 v[132:135], a[104:107], a[124:127], v[132:135]
    ds_read_b64_tr_b16 a[84:85], v204 offset:49152
    buffer_load_dwordx4 v243, s[40:43], s86 offen offset:2048 lds
    v_mfma_f32_16x16x32_bf16 v[136:139], a[108:111], a[124:127], v[136:139]
    ds_read_b64_tr_b16 a[86:87], v204 offset:51200
    s_waitcnt lgkmcnt(4)
    v_mfma_f32_16x16x32_bf16 v[76:79], a[176:179], a[80:83], v[76:79]
    s_add_u32 m0, s89, 118784
    v_mfma_f32_16x16x32_bf16 v[80:83], a[180:183], a[80:83], v[80:83]
    ds_read_b64_tr_b16 a[88:89], v234 offset:57344
    s_lshl_b32 s87, s88, 7
    s_waitcnt lgkmcnt(3)
    v_mfma_f32_16x16x32_bf16 v[84:87], a[72:75], a[80:83], v[84:87]
    ds_read_b64_tr_b16 a[90:91], v234 offset:59392
    buffer_load_dwordx4 v242, s[44:47], s86 offen lds
    v_mfma_f32_16x16x32_bf16 v[88:91], a[76:79], a[80:83], v[88:91]
    s_waitcnt lgkmcnt(2)
    v_mfma_f32_16x16x32_bf16 v[92:95], a[176:179], a[84:87], v[92:95]
    s_cmp_eq_u32 s81, 3
    s_cbranch_scc1 L_xd_a3
L_nx_a3:
    s_lshr_b32 s77, s92, 1
    s_and_b32 s78, s92, 1
    v_lshl_add_u32 v231, s78, 8, v231
    v_add_u32 v201, 65536, v224
    v_xor_b32 v200, 32, v201
    v_xor_b32 v199, 64, v201
    v_xor_b32 v198, 96, v201
    v_bfe_u32 v255, v0, 3, 2
    v_bfe_u32 v254, v0, 6, 1
    v_lshl_or_b32 v255, v254, 2, v255
    v_bfe_u32 v254, v0, 5, 1
    v_lshl_or_b32 v255, v254, 3, v255
    v_bfe_u32 v254, v0, 7, 1
    v_lshl_or_b32 v255, v254, 5, v255
    v_mul_u32_u24 v255, 3072, v255
    v_lshl_add_u32 v255, s94, 7, v255
    v_add_u32 v197, v255, v247
    v_add_u32 v196, 48128, v197
    s_lshl_b32 s23, s92, 11
    s_sub_u32 s16, s91, s81
    s_lshl2_add_u32 s80, s94, s92
    s_lshl_b32 s80, s80, 14
    s_add_u32 s80, s80, 262144
    s_and_b32 s79, s95, 12
    s_lshl_b32 s79, s79, 10
    v_mfma_f32_16x16x32_bf16 v[96:99], a[180:183], a[84:87], v[96:99]
    ds_read_b64_tr_b16 a[92:93], v204 offset:57344
    s_add_u32 s22, s80, s79
    s_xor_b32 s21, s22, 4096
    s_xor_b32 s20, s22, 8192
    s_xor_b32 s19, s22, 12288
    s_and_b32 s79, s95, 3
    v_lshl_add_u32 v195, s79, 10, v225
    v_lshl_add_u32 v194, s92, 11, v252
    v_add_u32 v194, 131072, v194
    v_lshl_add_u32 v193, s77, 10, v194
    v_and_b32 v193, 0xffffefff, v193
    v_lshrrev_b32 v192, 2, v194
    v_add_u32 v192, 106496, v192
    v_lshrrev_b32 v191, 2, v193
    v_add_u32 v191, 106496, v191
    v_mov_b32 v190, 0x3f80
    v_mov_b32 v189, 0x3f800000
    v_mov_b32 v72, 0x3f803f80
    v_mov_b32 v73, 0x3f803f80
    v_mov_b32 v74, 0x3f803f80
    v_mov_b32 v75, 0x3f803f80
    v_mov_b32 v186, 0x3fb8aa3b
    s_mov_b32 s17, 0x358637bd
    s_lshl1_add_u32 s80, s78, s77
    v_lshrrev_b32 v184, 1, v252
    v_add_u32 v184, 122880, v184
    v_mfma_f32_16x16x32_bf16 v[100:103], a[72:75], a[84:87], v[100:103]
    ds_read_b64_tr_b16 a[94:95], v204 offset:59392
    buffer_load_dwordx4 v241, s[44:47], s86 offen offset:2048 lds
    v_lshl_add_u32 v188, s80, 9, v184
    v_bfe_u32 v185, v0, 0, 4
    v_lshlrev_b32 v185, 1, v185
    v_add_u32 v185, 124928, v185
    v_lshl_add_u32 v185, s80, 9, v185
    v_bfe_u32 v183, v0, 4, 2
    v_lshlrev_b32 v183, 3, v183
    v_add_u32 v183, 124928, v183
    s_lshl1_add_u32 s80, s73, s78
    s_mul_i32 s80, s80, 98304
    s_lshl_b32 s79, s94, 12
    s_add_u32 s80, s80, s79
    s_add_u32 s18, s80, 1114112
    s_lshr_b32 s77, s92, 1
    s_lshr_b32 s79, s74, 1
    s_lshl1_add_u32 s80, s79, s77
    v_bfe_u32 v229, v0, 0, 3
    v_lshlrev_b32 v229, 7, v229
    v_lshl_add_u32 v229, s80, 10, v229
    s_mov_b32 s28, 131072
    s_mov_b32 s29, 65536
    s_mul_i32 s80, s74, 98304
    s_lshl_b32 s30, s77, 14
    s_lshl1_add_u32 s31, s30, s80
    s_add_u32 s31, s31, 1064960
    v_mfma_f32_16x16x32_bf16 v[104:107], a[76:79], a[84:87], v[104:107]
    s_add_u32 s30, s30, s80
    s_add_u32 s30, s30, 1114112
    s_mov_b32 s27, 0x10000
    s_mul_i32 s80, s77, 36864
    v_add_u32 v213, s80, v233
    v_xor_b32 v212, 64, v213
    v_xor_b32 v211, 4096, v213
    v_xor_b32 v210, 4096, v212
    v_bfe_u32 v255, v0, 4, 2
    v_lshlrev_b32 v255, 5, v255
    v_xor_b32 v255, v255, v252
    v_lshl_add_u32 v228, s92, 12, v255
    v_and_b32 v255, 0x8, v0
    v_bfe_u32 v254, v0, 4, 1
    v_lshl_or_b32 v255, v254, 0, v255
    v_bfe_u32 v254, v0, 5, 1
    v_lshl_or_b32 v255, v254, 4, v255
    v_bfe_u32 v254, v0, 6, 1
    v_lshl_or_b32 v255, v254, 2, v255
    v_lshl_add_u32 v255, s79, 6, v255
    v_bfe_u32 v254, v0, 0, 3
    v_lshlrev_b32 v254, 4, v254
    v_lshl_add_u32 v255, v255, 11, v254
    s_lshl1_add_u32 s80, s91, s77
    v_lshl_add_u32 v227, s80, 7, v255
    s_waitcnt lgkmcnt(2)
    v_mfma_f32_16x16x32_bf16 v[108:111], a[176:179], a[88:91], v[108:111]
    ds_read_b64_tr_b16 a[112:113], v234 offset:53248
    s_add_u32 m0, s89, 98304
    v_mfma_f32_16x16x32_bf16 v[112:115], a[180:183], a[88:91], v[112:115]
    ds_read_b64_tr_b16 a[114:115], v234 offset:55296
    s_add_u32 s88, s88, 1
    v_mfma_f32_16x16x32_bf16 v[116:119], a[72:75], a[88:91], v[116:119]
    ds_read_b128 a[184:187], v250 offset:32768
    buffer_load_dwordx4 v246, s[36:39], s87 offen lds
    v_mfma_f32_16x16x32_bf16 v[120:123], a[76:79], a[88:91], v[120:123]
    ds_read_b128 a[188:191], v250 offset:34816
    s_waitcnt lgkmcnt(4)
    v_mfma_f32_16x16x32_bf16 v[124:127], a[176:179], a[92:95], v[124:127]
    ds_read_b128 a[104:107], v237 offset:32768
    v_mfma_f32_16x16x32_bf16 v[128:131], a[180:183], a[92:95], v[128:131]
    ds_read_b128 a[108:111], v237 offset:34816
    v_mfma_f32_16x16x32_bf16 v[132:135], a[72:75], a[92:95], v[132:135]
    ds_read_b64_tr_b16 a[116:117], v204 offset:53248
    buffer_load_dwordx4 v246, s[36:39], s87 offen offset:2048 lds
    v_mfma_f32_16x16x32_bf16 v[136:139], a[76:79], a[92:95], v[136:139]
    ds_read_b64_tr_b16 a[118:119], v204 offset:55296
    s_waitcnt lgkmcnt(4)
    v_mfma_f32_16x16x32_bf16 v[76:79], a[184:187], a[112:115], v[76:79]
    s_add_u32 m0, s89, 102400
    v_mfma_f32_16x16x32_bf16 v[80:83], a[188:191], a[112:115], v[80:83]
    ds_read_b64_tr_b16 a[120:121], v234 offset:61440
    s_and_b32 s88, s88, 7
    s_waitcnt lgkmcnt(3)
    v_mfma_f32_16x16x32_bf16 v[84:87], a[104:107], a[112:115], v[84:87]
    ds_read_b64_tr_b16 a[122:123], v234 offset:63488
    buffer_load_dwordx4 v245, s[36:39], s87 offen lds
    v_mfma_f32_16x16x32_bf16 v[88:91], a[108:111], a[112:115], v[88:91]
    s_waitcnt lgkmcnt(2)
    v_mfma_f32_16x16x32_bf16 v[92:95], a[184:187], a[116:119], v[92:95]
    v_mfma_f32_16x16x32_bf16 v[96:99], a[188:191], a[116:119], v[96:99]
    ds_read_b64_tr_b16 a[124:125], v204 offset:61440
    v_mfma_f32_16x16x32_bf16 v[100:103], a[104:107], a[116:119], v[100:103]
    ds_read_b64_tr_b16 a[126:127], v204 offset:63488
    buffer_load_dwordx4 v245, s[36:39], s87 offen offset:2048 lds
    v_mfma_f32_16x16x32_bf16 v[104:107], a[108:111], a[116:119], v[104:107]
    s_waitcnt vmcnt(9)
    s_barrier
    s_waitcnt lgkmcnt(2)
    v_mfma_f32_16x16x32_bf16 v[108:111], a[184:187], a[120:123], v[108:111]
    ds_read_b64_tr_b16 a[80:81], v203 offset:16384
    s_add_u32 m0, s89, 16384
    v_mfma_f32_16x16x32_bf16 v[112:115], a[188:191], a[120:123], v[112:115]
    ds_read_b64_tr_b16 a[82:83], v203 offset:18432
    s_mul_i32 s86, s88, s83
    v_mfma_f32_16x16x32_bf16 v[116:119], a[104:107], a[120:123], v[116:119]
    ds_read_b128 a[192:195], v248 offset:0
    buffer_load_dwordx4 v244, s[40:43], s86 offen lds
    v_mfma_f32_16x16x32_bf16 v[120:123], a[108:111], a[120:123], v[120:123]
    ds_read_b128 a[196:199], v248 offset:2048
    s_waitcnt lgkmcnt(4)
    v_mfma_f32_16x16x32_bf16 v[124:127], a[184:187], a[124:127], v[124:127]
    ds_read_b128 a[72:75], v236 offset:0
    v_mfma_f32_16x16x32_bf16 v[128:131], a[188:191], a[124:127], v[128:131]
    ds_read_b128 a[76:79], v236 offset:2048
    v_mfma_f32_16x16x32_bf16 v[132:135], a[104:107], a[124:127], v[132:135]
    ds_read_b64_tr_b16 a[84:85], v202 offset:16384
    buffer_load_dwordx4 v243, s[40:43], s86 offen offset:2048 lds
    v_mfma_f32_16x16x32_bf16 v[136:139], a[108:111], a[124:127], v[136:139]
    ds_read_b64_tr_b16 a[86:87], v202 offset:18432
    s_waitcnt lgkmcnt(4)
    v_mfma_f32_16x16x32_bf16 v[76:79], a[192:195], a[80:83], v[76:79]
    s_add_u32 m0, s89, 20480
    v_mfma_f32_16x16x32_bf16 v[80:83], a[196:199], a[80:83], v[80:83]
    ds_read_b64_tr_b16 a[88:89], v203 offset:24576
    s_lshl_b32 s87, s88, 7
    s_waitcnt lgkmcnt(3)
    v_mfma_f32_16x16x32_bf16 v[84:87], a[72:75], a[80:83], v[84:87]
    ds_read_b64_tr_b16 a[90:91], v203 offset:26624
    buffer_load_dwordx4 v242, s[44:47], s86 offen lds
    v_mfma_f32_16x16x32_bf16 v[88:91], a[76:79], a[80:83], v[88:91]
    s_waitcnt lgkmcnt(2)
    v_mfma_f32_16x16x32_bf16 v[92:95], a[192:195], a[84:87], v[92:95]
    s_cmp_eq_u32 s81, 4
    s_cbranch_scc1 L_xd_a4
L_nx_a4:
    v_mfma_f32_16x16x32_bf16 v[96:99], a[196:199], a[84:87], v[96:99]
    ds_read_b64_tr_b16 a[92:93], v202 offset:24576
    v_mfma_f32_16x16x32_bf16 v[100:103], a[72:75], a[84:87], v[100:103]
    ds_read_b64_tr_b16 a[94:95], v202 offset:26624
    buffer_load_dwordx4 v241, s[44:47], s86 offen offset:2048 lds
    v_mfma_f32_16x16x32_bf16 v[104:107], a[76:79], a[84:87], v[104:107]
    s_waitcnt lgkmcnt(2)
    v_mfma_f32_16x16x32_bf16 v[108:111], a[192:195], a[88:91], v[108:111]
    ds_read_b64_tr_b16 a[112:113], v203 offset:20480
    s_add_u32 m0, s89, 0
    v_mfma_f32_16x16x32_bf16 v[112:115], a[196:199], a[88:91], v[112:115]
    ds_read_b64_tr_b16 a[114:115], v203 offset:22528
    s_add_u32 s88, s88, 1
    v_mfma_f32_16x16x32_bf16 v[116:119], a[72:75], a[88:91], v[116:119]
    ds_read_b128 a[200:203], v239 offset:0
    buffer_load_dwordx4 v246, s[36:39], s87 offen lds
    v_mfma_f32_16x16x32_bf16 v[120:123], a[76:79], a[88:91], v[120:123]
    ds_read_b128 a[204:207], v239 offset:2048
    s_waitcnt lgkmcnt(4)
    v_mfma_f32_16x16x32_bf16 v[124:127], a[192:195], a[92:95], v[124:127]
    ds_read_b128 a[104:107], v235 offset:0
    v_mfma_f32_16x16x32_bf16 v[128:131], a[196:199], a[92:95], v[128:131]
    ds_read_b128 a[108:111], v235 offset:2048
    v_mfma_f32_16x16x32_bf16 v[132:135], a[72:75], a[92:95], v[132:135]
    ds_read_b64_tr_b16 a[116:117], v202 offset:20480
    buffer_load_dwordx4 v246, s[36:39], s87 offen offset:2048 lds
    v_mfma_f32_16x16x32_bf16 v[136:139], a[76:79], a[92:95], v[136:139]
    ds_read_b64_tr_b16 a[118:119], v202 offset:22528
    s_waitcnt lgkmcnt(4)
    v_mfma_f32_16x16x32_bf16 v[76:79], a[200:203], a[112:115], v[76:79]
    s_add_u32 m0, s89, 4096
    v_mfma_f32_16x16x32_bf16 v[80:83], a[204:207], a[112:115], v[80:83]
    ds_read_b64_tr_b16 a[120:121], v203 offset:28672
    s_and_b32 s88, s88, 7
    s_waitcnt lgkmcnt(3)
    v_mfma_f32_16x16x32_bf16 v[84:87], a[104:107], a[112:115], v[84:87]
    ds_read_b64_tr_b16 a[122:123], v203 offset:30720
    buffer_load_dwordx4 v245, s[36:39], s87 offen lds
    v_mfma_f32_16x16x32_bf16 v[88:91], a[108:111], a[112:115], v[88:91]
    s_waitcnt lgkmcnt(2)
    v_mfma_f32_16x16x32_bf16 v[92:95], a[200:203], a[116:119], v[92:95]
    v_mfma_f32_16x16x32_bf16 v[96:99], a[204:207], a[116:119], v[96:99]
    ds_read_b64_tr_b16 a[124:125], v202 offset:28672
    v_mfma_f32_16x16x32_bf16 v[100:103], a[104:107], a[116:119], v[100:103]
    ds_read_b64_tr_b16 a[126:127], v202 offset:30720
    buffer_load_dwordx4 v245, s[36:39], s87 offen offset:2048 lds
    v_mfma_f32_16x16x32_bf16 v[104:107], a[108:111], a[116:119], v[104:107]
    s_waitcnt vmcnt(8)
    s_barrier
    s_waitcnt lgkmcnt(2)
    v_mfma_f32_16x16x32_bf16 v[108:111], a[200:203], a[120:123], v[108:111]
    ds_read_b64_tr_b16 a[80:81], v203 offset:49152
    s_add_u32 m0, s89, 49152
    v_mfma_f32_16x16x32_bf16 v[112:115], a[204:207], a[120:123], v[112:115]
    ds_read_b64_tr_b16 a[82:83], v203 offset:51200
    s_mul_i32 s86, s88, s83
    v_mfma_f32_16x16x32_bf16 v[116:119], a[104:107], a[120:123], v[116:119]
    ds_read_b128 a[208:211], v248 offset:32768
    buffer_load_dwordx4 v244, s[40:43], s86 offen lds
    v_mfma_f32_16x16x32_bf16 v[120:123], a[108:111], a[120:123], v[120:123]
    ds_read_b128 a[212:215], v248 offset:34816
    s_waitcnt lgkmcnt(4)
    v_mfma_f32_16x16x32_bf16 v[124:127], a[200:203], a[124:127], v[124:127]
    ds_read_b128 a[72:75], v236 offset:32768
    v_mfma_f32_16x16x32_bf16 v[128:131], a[204:207], a[124:127], v[128:131]
    ds_read_b128 a[76:79], v236 offset:34816
    v_mfma_f32_16x16x32_bf16 v[132:135], a[104:107], a[124:127], v[132:135]
    ds_read_b64_tr_b16 a[84:85], v202 offset:49152
    buffer_load_dwordx4 v243, s[40:43], s86 offen offset:2048 lds
    v_mfma_f32_16x16x32_bf16 v[136:139], a[108:111], a[124:127], v[136:139]
    ds_read_b64_tr_b16 a[86:87], v202 offset:51200
    s_waitcnt lgkmcnt(4)
    v_mfma_f32_16x16x32_bf16 v[76:79], a[208:211], a[80:83], v[76:79]
    s_add_u32 m0, s89, 53248
    v_mfma_f32_16x16x32_bf16 v[80:83], a[212:215], a[80:83], v[80:83]
    ds_read_b64_tr_b16 a[88:89], v203 offset:57344
    s_lshl_b32 s87, s88, 7
    s_waitcnt lgkmcnt(3)
    v_mfma_f32_16x16x32_bf16 v[84:87], a[72:75], a[80:83], v[84:87]
    ds_read_b64_tr_b16 a[90:91], v203 offset:59392
    buffer_load_dwordx4 v242, s[44:47], s86 offen lds
    v_mfma_f32_16x16x32_bf16 v[88:91], a[76:79], a[80:83], v[88:91]
    s_waitcnt lgkmcnt(2)
    v_mfma_f32_16x16x32_bf16 v[92:95], a[208:211], a[84:87], v[92:95]
    s_cmp_eq_u32 s81, 5
    s_cbranch_scc1 L_xd_a5
L_nx_a5:
    v_mfma_f32_16x16x32_bf16 v[96:99], a[212:215], a[84:87], v[96:99]
    ds_read_b64_tr_b16 a[92:93], v202 offset:57344
    v_mfma_f32_16x16x32_bf16 v[100:103], a[72:75], a[84:87], v[100:103]
    ds_read_b64_tr_b16 a[94:95], v202 offset:59392
    buffer_load_dwordx4 v241, s[44:47], s86 offen offset:2048 lds
    v_mfma_f32_16x16x32_bf16 v[104:107], a[76:79], a[84:87], v[104:107]
    s_waitcnt lgkmcnt(2)
    v_mfma_f32_16x16x32_bf16 v[108:111], a[208:211], a[88:91], v[108:111]
    ds_read_b64_tr_b16 a[112:113], v203 offset:53248
    s_add_u32 m0, s89, 32768
    v_mfma_f32_16x16x32_bf16 v[112:115], a[212:215], a[88:91], v[112:115]
    ds_read_b64_tr_b16 a[114:115], v203 offset:55296
    s_add_u32 s88, s88, 1
    v_mfma_f32_16x16x32_bf16 v[116:119], a[72:75], a[88:91], v[116:119]
    ds_read_b128 a[216:219], v239 offset:32768
    buffer_load_dwordx4 v246, s[36:39], s87 offen lds
    v_mfma_f32_16x16x32_bf16 v[120:123], a[76:79], a[88:91], v[120:123]
    ds_read_b128 a[220:223], v239 offset:34816
    s_waitcnt lgkmcnt(4)
    v_mfma_f32_16x16x32_bf16 v[124:127], a[208:211], a[92:95], v[124:127]
    ds_read_b128 a[104:107], v235 offset:32768
    v_mfma_f32_16x16x32_bf16 v[128:131], a[212:215], a[92:95], v[128:131]
    ds_read_b128 a[108:111], v235 offset:34816
    v_mfma_f32_16x16x32_bf16 v[132:135], a[72:75], a[92:95], v[132:135]
    ds_read_b64_tr_b16 a[116:117], v202 offset:53248
    buffer_load_dwordx4 v246, s[36:39], s87 offen offset:2048 lds
    v_mfma_f32_16x16x32_bf16 v[136:139], a[76:79], a[92:95], v[136:139]
    ds_read_b64_tr_b16 a[118:119], v202 offset:55296
    s_waitcnt lgkmcnt(4)
    v_mfma_f32_16x16x32_bf16 v[76:79], a[216:219], a[112:115], v[76:79]
    ds_read_b64_tr_b16 a[120:121], v203 offset:61440
    s_add_u32 m0, s89, 36864
    v_mfma_f32_16x16x32_bf16 v[80:83], a[220:223], a[112:115], v[80:83]
    ds_read_b64_tr_b16 a[122:123], v203 offset:63488
    s_and_b32 s88, s88, 7
    s_waitcnt lgkmcnt(4)
    v_mfma_f32_16x16x32_bf16 v[84:87], a[104:107], a[112:115], v[84:87]
    ds_read_b64_tr_b16 a[124:125], v202 offset:61440
    buffer_load_dwordx4 v245, s[36:39], s87 offen lds
    v_mfma_f32_16x16x32_bf16 v[88:91], a[108:111], a[112:115], v[88:91]
    ds_read_b64_tr_b16 a[126:127], v202 offset:63488
    s_waitcnt lgkmcnt(4)
    v_mfma_f32_16x16x32_bf16 v[92:95], a[216:219], a[116:119], v[92:95]
    v_mfma_f32_16x16x32_bf16 v[96:99], a[220:223], a[116:119], v[96:99]
    v_mfma_f32_16x16x32_bf16 v[100:103], a[104:107], a[116:119], v[100:103]
    buffer_load_dwordx4 v245, s[36:39], s87 offen offset:2048 lds
    v_mfma_f32_16x16x32_bf16 v[104:107], a[108:111], a[116:119], v[104:107]
    s_waitcnt vmcnt(8) lgkmcnt(0)
    s_barrier
    v_mfma_f32_16x16x32_bf16 v[108:111], a[216:219], a[120:123], v[108:111]
    ds_read_b64_tr_b16 a[80:81], v234 offset:16384
    buffer_load_dwordx4 v[68:71], v231, s[48:51], 0 offen sc1
    buffer_load_dwordx4 v[24:27], v230, s[48:51], 0 offen sc1
    s_add_u32 m0, s23, 65536
    s_add_u32 s80, s16, 0
    s_and_b32 s80, s80, 7
    v_mfma_f32_16x16x32_bf16 v[112:115], a[220:223], a[120:123], v[112:115]
    ds_read_b64_tr_b16 a[82:83], v234 offset:18432
    s_mul_i32 s80, s80, 196608
    v_mfma_f32_16x16x32_bf16 v[116:119], a[104:107], a[120:123], v[116:119]
    ds_read_b128 a[224:227], v251 offset:0
    buffer_load_dwordx4 v197, s[40:43], s80 offen lds
    v_mfma_f32_16x16x32_bf16 v[120:123], a[108:111], a[120:123], v[120:123]
    ds_read_b128 a[228:231], v251 offset:2048
    v_mfma_f32_16x16x32_bf16 v[124:127], a[216:219], a[124:127], v[124:127]
    ds_read_b128 a[72:75], v238 offset:0
    v_mfma_f32_16x16x32_bf16 v[128:131], a[220:223], a[124:127], v[128:131]
    ds_read_b128 a[76:79], v238 offset:2048
    v_mfma_f32_16x16x32_bf16 v[132:135], a[104:107], a[124:127], v[132:135]
    ds_read_b64_tr_b16 a[84:85], v204 offset:16384
    buffer_load_dwordx4 v196, s[40:43], s80 offen offset:1024 lds
    s_add_u32 m0, s23, 73728
    v_mfma_f32_16x16x32_bf16 v[136:139], a[108:111], a[124:127], v[136:139]
    ds_read_b64_tr_b16 a[86:87], v204 offset:18432
    s_add_u32 s80, s16, 1
    s_waitcnt lgkmcnt(4)
    v_mfma_f32_16x16x32_bf16 v[76:79], a[224:227], a[80:83], v[76:79]
    s_and_b32 s80, s80, 7
    v_mfma_f32_16x16x32_bf16 v[80:83], a[228:231], a[80:83], v[80:83]
    ds_read_b64_tr_b16 a[88:89], v234 offset:24576
    s_mul_i32 s80, s80, 196608
    s_waitcnt lgkmcnt(3)
    v_mfma_f32_16x16x32_bf16 v[84:87], a[72:75], a[80:83], v[84:87]
    ds_read_b64_tr_b16 a[90:91], v234 offset:26624
    buffer_load_dwordx4 v197, s[40:43], s80 offen lds
    v_mfma_f32_16x16x32_bf16 v[88:91], a[76:79], a[80:83], v[88:91]
    s_waitcnt lgkmcnt(2)
    v_mfma_f32_16x16x32_bf16 v[92:95], a[224:227], a[84:87], v[92:95]
    s_cmp_eq_u32 s81, 6
    s_cbranch_scc1 L_xd_a6
L_nx_a6:
    v_mfma_f32_16x16x32_bf16 v[96:99], a[228:231], a[84:87], v[96:99]
    ds_read_b64_tr_b16 a[92:93], v204 offset:24576
    v_mfma_f32_16x16x32_bf16 v[100:103], a[72:75], a[84:87], v[100:103]
    ds_read_b64_tr_b16 a[94:95], v204 offset:26624
    buffer_load_dwordx4 v196, s[40:43], s80 offen offset:1024 lds
    s_add_u32 m0, s23, 81920
    v_mfma_f32_16x16x32_bf16 v[104:107], a[76:79], a[84:87], v[104:107]
    s_add_u32 s80, s16, 2
    s_waitcnt lgkmcnt(2)
    v_mfma_f32_16x16x32_bf16 v[108:111], a[224:227], a[88:91], v[108:111]
    ds_read_b64_tr_b16 a[112:113], v234 offset:20480
    s_and_b32 s80, s80, 7
    v_mfma_f32_16x16x32_bf16 v[112:115], a[228:231], a[88:91], v[112:115]
    ds_read_b64_tr_b16 a[114:115], v234 offset:22528
    s_mul_i32 s80, s80, 196608
    v_mfma_f32_16x16x32_bf16 v[116:119], a[72:75], a[88:91], v[116:119]
    ds_read_b128 a[232:235], v250 offset:0
    buffer_load_dwordx4 v197, s[40:43], s80 offen lds
    v_mfma_f32_16x16x32_bf16 v[120:123], a[76:79], a[88:91], v[120:123]
    ds_read_b128 a[236:239], v250 offset:2048
    s_waitcnt lgkmcnt(4)
    v_mfma_f32_16x16x32_bf16 v[124:127], a[224:227], a[92:95], v[124:127]
    ds_read_b128 a[104:107], v237 offset:0
    v_mfma_f32_16x16x32_bf16 v[128:131], a[228:231], a[92:95], v[128:131]
    ds_read_b128 a[108:111], v237 offset:2048
    v_mfma_f32_16x16x32_bf16 v[132:135], a[72:75], a[92:95], v[132:135]
    ds_read_b64_tr_b16 a[116:117], v204 offset:20480
    buffer_load_dwordx4 v196, s[40:43], s80 offen offset:1024 lds
    s_add_u32 m0, s23, 90112
    v_mfma_f32_16x16x32_bf16 v[136:139], a[76:79], a[92:95], v[136:139]
    ds_read_b64_tr_b16 a[118:119], v204 offset:22528
    s_add_u32 s80, s16, 3
    s_waitcnt lgkmcnt(4)
    v_mfma_f32_16x16x32_bf16 v[76:79], a[232:235], a[112:115], v[76:79]
    ds_read_b64_tr_b16 a[120:121], v234 offset:28672
    s_and_b32 s80, s80, 7
    v_mfma_f32_16x16x32_bf16 v[80:83], a[236:239], a[112:115], v[80:83]
    ds_read_b64_tr_b16 a[122:123], v234 offset:30720
    s_mul_i32 s80, s80, 196608
    s_waitcnt lgkmcnt(4)
    v_mfma_f32_16x16x32_bf16 v[84:87], a[104:107], a[112:115], v[84:87]
    ds_read_b64_tr_b16 a[124:125], v204 offset:28672
    buffer_load_dwordx4 v197, s[40:43], s80 offen lds
    v_mfma_f32_16x16x32_bf16 v[88:91], a[108:111], a[112:115], v[88:91]
    ds_read_b64_tr_b16 a[126:127], v204 offset:30720
    s_waitcnt lgkmcnt(4)
    v_mfma_f32_16x16x32_bf16 v[92:95], a[232:235], a[116:119], v[92:95]
    v_mfma_f32_16x16x32_bf16 v[96:99], a[236:239], a[116:119], v[96:99]
    v_mfma_f32_16x16x32_bf16 v[100:103], a[104:107], a[116:119], v[100:103]
    buffer_load_dwordx4 v196, s[40:43], s80 offen offset:1024 lds
    v_mfma_f32_16x16x32_bf16 v[104:107], a[108:111], a[116:119], v[104:107]
    s_waitcnt vmcnt(10) lgkmcnt(0)
    s_barrier
    v_mfma_f32_16x16x32_bf16 v[108:111], a[232:235], a[120:123], v[108:111]
    ds_read_b64_tr_b16 a[80:81], v234 offset:49152
    s_add_u32 m0, s23, 98304
    s_add_u32 s80, s16, 4
    s_and_b32 s80, s80, 7
    v_mfma_f32_16x16x32_bf16 v[112:115], a[236:239], a[120:123], v[112:115]
    ds_read_b64_tr_b16 a[82:83], v234 offset:51200
    s_mul_i32 s80, s80, 196608
    v_mfma_f32_16x16x32_bf16 v[116:119], a[104:107], a[120:123], v[116:119]
    ds_read_b128 a[240:243], v251 offset:32768
    buffer_load_dwordx4 v197, s[40:43], s80 offen lds
    v_mfma_f32_16x16x32_bf16 v[120:123], a[108:111], a[120:123], v[120:123]
    ds_read_b128 a[244:247], v251 offset:34816
    v_mfma_f32_16x16x32_bf16 v[124:127], a[232:235], a[124:127], v[124:127]
    ds_read_b128 a[72:75], v238 offset:32768
    v_mfma_f32_16x16x32_bf16 v[128:131], a[236:239], a[124:127], v[128:131]
    ds_read_b128 a[76:79], v238 offset:34816
    v_mfma_f32_16x16x32_bf16 v[132:135], a[104:107], a[124:127], v[132:135]
    ds_read_b64_tr_b16 a[84:85], v204 offset:49152
    buffer_load_dwordx4 v196, s[40:43], s80 offen offset:1024 lds
    s_add_u32 m0, s23, 106496
    v_mfma_f32_16x16x32_bf16 v[136:139], a[108:111], a[124:127], v[136:139]
    ds_read_b64_tr_b16 a[86:87], v204 offset:51200
    s_add_u32 s80, s16, 5
    s_waitcnt lgkmcnt(4)
    v_mfma_f32_16x16x32_bf16 v[76:79], a[240:243], a[80:83], v[76:79]
    s_and_b32 s80, s80, 7
    v_mfma_f32_16x16x32_bf16 v[80:83], a[244:247], a[80:83], v[80:83]
    ds_read_b64_tr_b16 a[88:89], v234 offset:57344
    s_mul_i32 s80, s80, 196608
    s_waitcnt lgkmcnt(3)
    v_mfma_f32_16x16x32_bf16 v[84:87], a[72:75], a[80:83], v[84:87]
    ds_read_b64_tr_b16 a[90:91], v234 offset:59392
    buffer_load_dwordx4 v197, s[40:43], s80 offen lds
    v_mfma_f32_16x16x32_bf16 v[88:91], a[76:79], a[80:83], v[88:91]
    s_waitcnt lgkmcnt(2)
    v_mfma_f32_16x16x32_bf16 v[92:95], a[240:243], a[84:87], v[92:95]
    s_cmp_eq_u32 s81, 7
    s_cbranch_scc1 L_xd_a7
L_nx_a7:
    v_mfma_f32_16x16x32_bf16 v[96:99], a[244:247], a[84:87], v[96:99]
    ds_read_b64_tr_b16 a[92:93], v204 offset:57344
    v_mfma_f32_16x16x32_bf16 v[100:103], a[72:75], a[84:87], v[100:103]
    ds_read_b64_tr_b16 a[94:95], v204 offset:59392
    buffer_load_dwordx4 v196, s[40:43], s80 offen offset:1024 lds
    s_add_u32 m0, s23, 114688
    v_mfma_f32_16x16x32_bf16 v[104:107], a[76:79], a[84:87], v[104:107]
    s_add_u32 s80, s16, 6
    s_waitcnt lgkmcnt(2)
    v_mfma_f32_16x16x32_bf16 v[108:111], a[240:243], a[88:91], v[108:111]
    ds_read_b64_tr_b16 a[112:113], v234 offset:53248
    s_and_b32 s80, s80, 7
    v_mfma_f32_16x16x32_bf16 v[112:115], a[244:247], a[88:91], v[112:115]
    ds_read_b64_tr_b16 a[114:115], v234 offset:55296
    s_mul_i32 s80, s80, 196608
    v_mfma_f32_16x16x32_bf16 v[116:119], a[72:75], a[88:91], v[116:119]
    ds_read_b128 a[248:251], v250 offset:32768
    buffer_load_dwordx4 v197, s[40:43], s80 offen lds
    v_mfma_f32_16x16x32_bf16 v[120:123], a[76:79], a[88:91], v[120:123]
    ds_read_b128 a[252:255], v250 offset:34816
    s_waitcnt lgkmcnt(4)
    v_mfma_f32_16x16x32_bf16 v[124:127], a[240:243], a[92:95], v[124:127]
    ds_read_b128 a[104:107], v237 offset:32768
    v_mfma_f32_16x16x32_bf16 v[128:131], a[244:247], a[92:95], v[128:131]
    ds_read_b128 a[108:111], v237 offset:34816
    v_mfma_f32_16x16x32_bf16 v[132:135], a[72:75], a[92:95], v[132:135]
    ds_read_b64_tr_b16 a[116:117], v204 offset:53248
    buffer_load_dwordx4 v196, s[40:43], s80 offen offset:1024 lds
    s_add_u32 m0, s23, 122880
    v_mfma_f32_16x16x32_bf16 v[136:139], a[76:79], a[92:95], v[136:139]
    ds_read_b64_tr_b16 a[118:119], v204 offset:55296
    s_add_u32 s80, s16, 7
    s_waitcnt lgkmcnt(4)
    v_mfma_f32_16x16x32_bf16 v[76:79], a[248:251], a[112:115], v[76:79]
    s_and_b32 s80, s80, 7
    v_mfma_f32_16x16x32_bf16 v[80:83], a[252:255], a[112:115], v[80:83]
    ds_read_b64_tr_b16 a[120:121], v234 offset:61440
    s_mul_i32 s80, s80, 196608
    s_waitcnt lgkmcnt(3)
    v_mfma_f32_16x16x32_bf16 v[84:87], a[104:107], a[112:115], v[84:87]
    ds_read_b64_tr_b16 a[122:123], v234 offset:63488
    buffer_load_dwordx4 v197, s[40:43], s80 offen lds
    v_mfma_f32_16x16x32_bf16 v[88:91], a[108:111], a[112:115], v[88:91]
    s_waitcnt lgkmcnt(2)
    v_mfma_f32_16x16x32_bf16 v[92:95], a[248:251], a[116:119], v[92:95]
    v_mfma_f32_16x16x32_bf16 v[96:99], a[252:255], a[116:119], v[96:99]
    ds_read_b64_tr_b16 a[124:125], v204 offset:61440
    v_mfma_f32_16x16x32_bf16 v[100:103], a[104:107], a[116:119], v[100:103]
    ds_read_b64_tr_b16 a[126:127], v204 offset:63488
    buffer_load_dwordx4 v196, s[40:43], s80 offen offset:1024 lds
    v_mfma_f32_16x16x32_bf16 v[104:107], a[108:111], a[116:119], v[104:107]
    s_waitcnt lgkmcnt(2)
    v_mfma_f32_16x16x32_bf16 v[108:111], a[248:251], a[120:123], v[108:111]
    v_mfma_f32_16x16x32_bf16 v[112:115], a[252:255], a[120:123], v[112:115]
    v_mfma_f32_16x16x32_bf16 v[116:119], a[104:107], a[120:123], v[116:119]
    v_mfma_f32_16x16x32_bf16 v[120:123], a[108:111], a[120:123], v[120:123]
    s_waitcnt lgkmcnt(0)
    v_mfma_f32_16x16x32_bf16 v[124:127], a[248:251], a[124:127], v[124:127]
    v_mfma_f32_16x16x32_bf16 v[128:131], a[252:255], a[124:127], v[128:131]
    v_mfma_f32_16x16x32_bf16 v[132:135], a[104:107], a[124:127], v[132:135]
    v_mfma_f32_16x16x32_bf16 v[136:139], a[108:111], a[124:127], v[136:139]
    v_pk_mul_f32 v[140:141], v[186:187], v[76:77] op_sel_hi:[0,1]
    v_pk_mul_f32 v[142:143], v[186:187], v[78:79] op_sel_hi:[0,1]
    v_pk_mul_f32 v[144:145], v[186:187], v[80:81] op_sel_hi:[0,1]
    v_pk_mul_f32 v[146:147], v[186:187], v[82:83] op_sel_hi:[0,1]
    v_exp_f32 v140, v140 clamp
    v_max_f32 v76, s17, v76
    v_exp_f32 v141, v141 clamp
    v_max_f32 v77, s17, v77
    v_exp_f32 v142, v142 clamp
    v_max_f32 v78, s17, v78
    v_exp_f32 v143, v143 clamp
    v_max_f32 v79, s17, v79
    v_exp_f32 v144, v144 clamp
L_pg3011:
    s_cbranch_execz L_backa
    v_max_f32 v80, s17, v80
    v_exp_f32 v145, v145 clamp
    v_max_f32 v81, s17, v81
    v_exp_f32 v146, v146 clamp
    v_max_f32 v82, s17, v82
    v_exp_f32 v147, v147 clamp
    v_max_f32 v83, s17, v83
    v_pk_add_f32 v[76:77], v[76:77], v[140:141]
    v_pk_add_f32 v[78:79], v[78:79], v[142:143]
    v_pk_add_f32 v[80:81], v[80:81], v[144:145]
    v_pk_add_f32 v[82:83], v[82:83], v[146:147]
    v_cvt_pk_bf16_f32 v148, v76, v77
    v_cvt_pk_bf16_f32 v149, v78, v79
    v_cvt_pk_bf16_f32 v150, v80, v81
    v_cvt_pk_bf16_f32 v151, v82, v83
    v_cvt_pk_bf16_f32 v164, v108, v109
    v_cvt_pk_bf16_f32 v165, v110, v111
    v_cvt_pk_bf16_f32 v166, v112, v113
    s_xor_b32 m0, s75, 0
    s_xor_b32 s87, s33, 0
    buffer_load_dwordx4 v219, s[56:59], s87 offen lds
    v_cvt_pk_bf16_f32 v167, v114, v115
    v_pk_mul_f32 v[140:141], v[186:187], v[84:85] op_sel_hi:[0,1]
    v_pk_mul_f32 v[142:143], v[186:187], v[86:87] op_sel_hi:[0,1]
    v_pk_mul_f32 v[144:145], v[186:187], v[88:89] op_sel_hi:[0,1]
    v_pk_mul_f32 v[146:147], v[186:187], v[90:91] op_sel_hi:[0,1]
    v_exp_f32 v140, v140 clamp
    v_mfma_f32_16x16x32_bf16 v[44:47], v[72:75], v[148:151], 0
    v_max_f32 v84, s17, v84
    v_exp_f32 v141, v141 clamp
    v_max_f32 v85, s17, v85
    buffer_load_dwordx4 v218, s[56:59], s87 offen offset:2048 lds
    v_exp_f32 v142, v142 clamp
    v_max_f32 v86, s17, v86
    v_exp_f32 v143, v143 clamp
    v_max_f32 v87, s17, v87
    v_mfma_f32_16x16x32_bf16 v[36:39], v[148:151], v[164:167], 0
    v_exp_f32 v144, v144 clamp
    v_max_f32 v88, s17, v88
    v_exp_f32 v145, v145 clamp
    v_max_f32 v89, s17, v89
    v_exp_f32 v146, v146 clamp
    s_xor_b32 m0, s75, 8192
    s_xor_b32 s87, s33, 128
    buffer_load_dwordx4 v219, s[56:59], s87 offen lds
    v_max_f32 v90, s17, v90
    v_exp_f32 v147, v147 clamp
    v_max_f32 v91, s17, v91
    v_pk_add_f32 v[84:85], v[84:85], v[140:141]
    v_pk_add_f32 v[86:87], v[86:87], v[142:143]
    v_pk_add_f32 v[88:89], v[88:89], v[144:145]
    v_pk_add_f32 v[90:91], v[90:91], v[146:147]
    v_cvt_pk_bf16_f32 v152, v84, v85
    v_cvt_pk_bf16_f32 v153, v86, v87
    v_cvt_pk_bf16_f32 v154, v88, v89
    buffer_load_dwordx4 v218, s[56:59], s87 offen offset:2048 lds
    v_cvt_pk_bf16_f32 v155, v90, v91
    v_cvt_pk_bf16_f32 v168, v116, v117
    v_cvt_pk_bf16_f32 v169, v118, v119
    v_cvt_pk_bf16_f32 v170, v120, v121
    v_cvt_pk_bf16_f32 v171, v122, v123
    v_pk_mul_f32 v[140:141], v[186:187], v[92:93] op_sel_hi:[0,1]
    v_pk_mul_f32 v[142:143], v[186:187], v[94:95] op_sel_hi:[0,1]
    v_pk_mul_f32 v[144:145], v[186:187], v[96:97] op_sel_hi:[0,1]
    v_pk_mul_f32 v[146:147], v[186:187], v[98:99] op_sel_hi:[0,1]
    v_exp_f32 v140, v140 clamp
    s_xor_b32 m0, s75, 16384
    s_xor_b32 s87, s33, 256
    buffer_load_dwordx4 v219, s[56:59], s87 offen lds
    v_mfma_f32_16x16x32_bf16 v[44:47], v[72:75], v[152:155], v[44:47]
    v_max_f32 v92, s17, v92
    v_exp_f32 v141, v141 clamp
    v_max_f32 v93, s17, v93
    v_exp_f32 v142, v142 clamp
    v_max_f32 v94, s17, v94
    v_exp_f32 v143, v143 clamp
    v_max_f32 v95, s17, v95
    v_mfma_f32_16x16x32_bf16 v[36:39], v[152:155], v[168:171], v[36:39]
    v_exp_f32 v144, v144 clamp
    buffer_load_dwordx4 v218, s[56:59], s87 offen offset:2048 lds
    v_max_f32 v96, s17, v96
    v_exp_f32 v145, v145 clamp
    v_max_f32 v97, s17, v97
    v_exp_f32 v146, v146 clamp
    v_max_f32 v98, s17, v98
    v_exp_f32 v147, v147 clamp
    v_max_f32 v99, s17, v99
    v_pk_add_f32 v[92:93], v[92:93], v[140:141]
    v_pk_add_f32 v[94:95], v[94:95], v[142:143]
    v_pk_add_f32 v[96:97], v[96:97], v[144:145]
    s_xor_b32 m0, s75, 24576
    s_xor_b32 s87, s33, 384
    buffer_load_dwordx4 v219, s[56:59], s87 offen lds
    v_pk_add_f32 v[98:99], v[98:99], v[146:147]
    v_cvt_pk_bf16_f32 v156, v92, v93
    v_cvt_pk_bf16_f32 v157, v94, v95
    v_cvt_pk_bf16_f32 v158, v96, v97
    v_cvt_pk_bf16_f32 v159, v98, v99
    v_cvt_pk_bf16_f32 v172, v124, v125
    v_cvt_pk_bf16_f32 v173, v126, v127
    v_cvt_pk_bf16_f32 v174, v128, v129
    v_cvt_pk_bf16_f32 v175, v130, v131
    v_pk_mul_f32 v[140:141], v[186:187], v[100:101] op_sel_hi:[0,1]
    buffer_load_dwordx4 v218, s[56:59], s87 offen offset:2048 lds
    v_pk_mul_f32 v[142:143], v[186:187], v[102:103] op_sel_hi:[0,1]
    v_pk_mul_f32 v[144:145], v[186:187], v[104:105] op_sel_hi:[0,1]
    v_pk_mul_f32 v[146:147], v[186:187], v[106:107] op_sel_hi:[0,1]
    v_exp_f32 v140, v140 clamp
    v_mfma_f32_16x16x32_bf16 v[48:51], v[72:75], v[156:159], 0
    v_max_f32 v100, s17, v100
    v_exp_f32 v141, v141 clamp
    v_max_f32 v101, s17, v101
    v_exp_f32 v142, v142 clamp
    v_max_f32 v102, s17, v102
    v_exp_f32 v143, v143 clamp
    v_max_f32 v103, s17, v103
    v_mfma_f32_16x16x32_bf16 v[40:43], v[156:159], v[172:175], 0
    v_exp_f32 v144, v144 clamp
    v_max_f32 v104, s17, v104
    v_exp_f32 v145, v145 clamp
    v_max_f32 v105, s17, v105
    v_exp_f32 v146, v146 clamp
    v_max_f32 v106, s17, v106
    v_exp_f32 v147, v147 clamp
    v_max_f32 v107, s17, v107
    v_pk_add_f32 v[100:101], v[100:101], v[140:141]
    v_pk_add_f32 v[102:103], v[102:103], v[142:143]
    v_pk_add_f32 v[104:105], v[104:105], v[144:145]
    v_pk_add_f32 v[106:107], v[106:107], v[146:147]
    v_cvt_pk_bf16_f32 v160, v100, v101
    v_cvt_pk_bf16_f32 v161, v102, v103
    v_cvt_pk_bf16_f32 v162, v104, v105
    v_cvt_pk_bf16_f32 v163, v106, v107
    ds_write_b128 v194, v[36:39]
    v_cvt_pk_bf16_f32 v176, v132, v133
    v_cvt_pk_bf16_f32 v177, v134, v135
    v_mfma_f32_16x16x32_bf16 v[48:51], v[72:75], v[160:163], v[48:51]
    v_cvt_pk_bf16_f32 v178, v136, v137
    v_cvt_pk_bf16_f32 v179, v138, v139
    s_nop 1
    v_mfma_f32_16x16x32_bf16 v[40:43], v[160:163], v[176:179], v[40:43]
    v_mov_b32 v67, v240
    s_nop 1
    ds_write2st64_b32 v192, v44, v48 offset0:0 offset1:1
    s_nop 3
    ds_write_b128 v194, v[40:43] offset:1024
    s_waitcnt vmcnt(8) lgkmcnt(0)
    s_barrier
    ds_read_b128 v[52:55], v193
    ds_read_b128 v[56:59], v193 offset:4096
    ds_read2st64_b32 v[60:61], v191 offset0:0 offset1:4
    ds_read_b64_tr_b16 a[64:65], v201 offset:0
    ds_read_b64_tr_b16 a[66:67], v201 offset:2048
    ds_read_b64_tr_b16 a[68:69], v200 offset:0
    ds_read_b64_tr_b16 a[70:71], v200 offset:2048
    ds_read_b64_tr_b16 a[72:73], v201 offset:4096
    ds_read_b64_tr_b16 a[74:75], v201 offset:6144
    ds_read_b64_tr_b16 a[76:77], v200 offset:4096
    ds_read_b64_tr_b16 a[78:79], v200 offset:6144
    s_waitcnt lgkmcnt(9)
    v_pk_add_f32 v[52:53], v[52:53], v[56:57]
    v_pk_add_f32 v[54:55], v[54:55], v[58:59]
    v_cvt_pk_bf16_f32 v64, v52, v53
    v_cvt_pk_bf16_f32 v65, v54, v55
    s_waitcnt lgkmcnt(8)
    v_add_f32 v66, v60, v61
    buffer_store_dwordx4 v[64:67], v195, s[48:51], s22 offen sc1
    s_waitcnt lgkmcnt(4)
    v_mfma_f32_16x16x32_bf16 v[36:39], a[64:67], a[128:131], 0
    ds_read_b64_tr_b16 a[80:81], v201 offset:8192
    s_xor_b32 m0, s75, 32768
    v_mfma_f32_16x16x32_bf16 v[40:43], a[64:67], a[132:135], 0
    ds_read_b64_tr_b16 a[82:83], v201 offset:10240
    s_xor_b32 s87, s33, 512
    v_mfma_f32_16x16x32_bf16 v[44:47], a[68:71], a[128:131], 0
    ds_read_b64_tr_b16 a[84:85], v200 offset:8192
    buffer_load_dwordx4 v219, s[56:59], s87 offen lds
    v_mfma_f32_16x16x32_bf16 v[48:51], a[68:71], a[132:135], 0
    ds_read_b64_tr_b16 a[86:87], v200 offset:10240
    s_waitcnt lgkmcnt(4)
    v_mfma_f32_16x16x32_bf16 v[36:39], a[72:75], a[136:139], v[36:39]
    ds_read_b64_tr_b16 a[88:89], v201 offset:12288
    v_mfma_f32_16x16x32_bf16 v[40:43], a[72:75], a[140:143], v[40:43]
    ds_read_b64_tr_b16 a[90:91], v201 offset:14336
    v_mfma_f32_16x16x32_bf16 v[44:47], a[76:79], a[136:139], v[44:47]
    ds_read_b64_tr_b16 a[92:93], v200 offset:12288
    buffer_load_dwordx4 v218, s[56:59], s87 offen offset:2048 lds
    v_mfma_f32_16x16x32_bf16 v[48:51], a[76:79], a[140:143], v[48:51]
    ds_read_b64_tr_b16 a[94:95], v200 offset:14336
    s_waitcnt lgkmcnt(4)
    v_mfma_f32_16x16x32_bf16 v[36:39], a[80:83], a[144:147], v[36:39]
    ds_read_b64_tr_b16 a[64:65], v201 offset:16384
    s_xor_b32 m0, s75, 40960
    v_mfma_f32_16x16x32_bf16 v[40:43], a[80:83], a[148:151], v[40:43]
    ds_read_b64_tr_b16 a[66:67], v201 offset:18432
    s_xor_b32 s87, s33, 640
    v_mfma_f32_16x16x32_bf16 v[44:47], a[84:87], a[144:147], v[44:47]
    ds_read_b64_tr_b16 a[68:69], v200 offset:16384
    buffer_load_dwordx4 v219, s[56:59], s87 offen lds
    v_mfma_f32_16x16x32_bf16 v[48:51], a[84:87], a[148:151], v[48:51]
    ds_read_b64_tr_b16 a[70:71], v200 offset:18432
    s_waitcnt lgkmcnt(4)
    v_mfma_f32_16x16x32_bf16 v[36:39], a[88:91], a[152:155], v[36:39]
    ds_read_b64_tr_b16 a[72:73], v201 offset:20480
    v_mfma_f32_16x16x32_bf16 v[40:43], a[88:91], a[156:159], v[40:43]
    ds_read_b64_tr_b16 a[74:75], v201 offset:22528
    v_mfma_f32_16x16x32_bf16 v[44:47], a[92:95], a[152:155], v[44:47]
    ds_read_b64_tr_b16 a[76:77], v200 offset:20480
    buffer_load_dwordx4 v218, s[56:59], s87 offen offset:2048 lds
    v_mfma_f32_16x16x32_bf16 v[48:51], a[92:95], a[156:159], v[48:51]
    ds_read_b64_tr_b16 a[78:79], v200 offset:22528
    s_waitcnt lgkmcnt(4)
    v_mfma_f32_16x16x32_bf16 v[36:39], a[64:67], a[160:163], v[36:39]
    ds_read_b64_tr_b16 a[80:81], v201 offset:24576
    s_xor_b32 m0, s75, 49152
    v_mfma_f32_16x16x32_bf16 v[40:43], a[64:67], a[164:167], v[40:43]
    ds_read_b64_tr_b16 a[82:83], v201 offset:26624
    s_xor_b32 s87, s33, 768
    v_mfma_f32_16x16x32_bf16 v[44:47], a[68:71], a[160:163], v[44:47]
    ds_read_b64_tr_b16 a[84:85], v200 offset:24576
    buffer_load_dwordx4 v219, s[56:59], s87 offen lds
    v_mfma_f32_16x16x32_bf16 v[48:51], a[68:71], a[164:167], v[48:51]
    ds_read_b64_tr_b16 a[86:87], v200 offset:26624
    s_waitcnt lgkmcnt(4)
    v_mfma_f32_16x16x32_bf16 v[36:39], a[72:75], a[168:171], v[36:39]
    ds_read_b64_tr_b16 a[88:89], v201 offset:28672
    v_mfma_f32_16x16x32_bf16 v[40:43], a[72:75], a[172:175], v[40:43]
    ds_read_b64_tr_b16 a[90:91], v201 offset:30720
    v_mfma_f32_16x16x32_bf16 v[44:47], a[76:79], a[168:171], v[44:47]
    ds_read_b64_tr_b16 a[92:93], v200 offset:28672
    buffer_load_dwordx4 v218, s[56:59], s87 offen offset:2048 lds
    v_mfma_f32_16x16x32_bf16 v[48:51], a[76:79], a[172:175], v[48:51]
    ds_read_b64_tr_b16 a[94:95], v200 offset:30720
    s_waitcnt lgkmcnt(4)
    v_mfma_f32_16x16x32_bf16 v[36:39], a[80:83], a[176:179], v[36:39]
    ds_read_b64_tr_b16 a[64:65], v201 offset:32768
    s_xor_b32 m0, s75, 57344
    v_mfma_f32_16x16x32_bf16 v[40:43], a[80:83], a[180:183], v[40:43]
    ds_read_b64_tr_b16 a[66:67], v201 offset:34816
    s_xor_b32 s87, s33, 896
    v_mfma_f32_16x16x32_bf16 v[44:47], a[84:87], a[176:179], v[44:47]
    ds_read_b64_tr_b16 a[68:69], v200 offset:32768
    buffer_load_dwordx4 v219, s[56:59], s87 offen lds
    v_mfma_f32_16x16x32_bf16 v[48:51], a[84:87], a[180:183], v[48:51]
    ds_read_b64_tr_b16 a[70:71], v200 offset:34816
    s_waitcnt lgkmcnt(4)
    v_mfma_f32_16x16x32_bf16 v[36:39], a[88:91], a[184:187], v[36:39]
    ds_read_b64_tr_b16 a[72:73], v201 offset:36864
    v_mfma_f32_16x16x32_bf16 v[40:43], a[88:91], a[188:191], v[40:43]
    ds_read_b64_tr_b16 a[74:75], v201 offset:38912
    v_mfma_f32_16x16x32_bf16 v[44:47], a[92:95], a[184:187], v[44:47]
    ds_read_b64_tr_b16 a[76:77], v200 offset:36864
    buffer_load_dwordx4 v218, s[56:59], s87 offen offset:2048 lds
    v_mfma_f32_16x16x32_bf16 v[48:51], a[92:95], a[188:191], v[48:51]
    ds_read_b64_tr_b16 a[78:79], v200 offset:38912
    s_barrier
    s_waitcnt lgkmcnt(4)
    v_mfma_f32_16x16x32_bf16 v[36:39], a[64:67], a[192:195], v[36:39]
    ds_read_b64_tr_b16 a[80:81], v201 offset:40960
    s_add_u32 m0, s76, 131072
    v_mfma_f32_16x16x32_bf16 v[40:43], a[64:67], a[196:199], v[40:43]
    ds_read_b64_tr_b16 a[82:83], v201 offset:43008
    s_xor_b32 s87, s32, 0
    v_mfma_f32_16x16x32_bf16 v[44:47], a[68:71], a[192:195], v[44:47]
    ds_read_b64_tr_b16 a[84:85], v200 offset:40960
    buffer_load_dwordx4 v223, s[60:63], s87 offen lds
    v_mfma_f32_16x16x32_bf16 v[48:51], a[68:71], a[196:199], v[48:51]
    ds_read_b64_tr_b16 a[86:87], v200 offset:43008
    s_waitcnt lgkmcnt(4)
    v_mfma_f32_16x16x32_bf16 v[36:39], a[72:75], a[200:203], v[36:39]
    ds_read_b64_tr_b16 a[88:89], v201 offset:45056
    v_mfma_f32_16x16x32_bf16 v[40:43], a[72:75], a[204:207], v[40:43]
    ds_read_b64_tr_b16 a[90:91], v201 offset:47104
    v_mfma_f32_16x16x32_bf16 v[44:47], a[76:79], a[200:203], v[44:47]
    ds_read_b64_tr_b16 a[92:93], v200 offset:45056
    buffer_load_dwordx4 v222, s[60:63], s87 offen offset:1024 lds
    v_mfma_f32_16x16x32_bf16 v[48:51], a[76:79], a[204:207], v[48:51]
    ds_read_b64_tr_b16 a[94:95], v200 offset:47104
    s_waitcnt lgkmcnt(4)
    v_mfma_f32_16x16x32_bf16 v[36:39], a[80:83], a[208:211], v[36:39]
    ds_read_b64_tr_b16 a[64:65], v201 offset:49152
    v_mfma_f32_16x16x32_bf16 v[40:43], a[80:83], a[212:215], v[40:43]
    ds_read_b64_tr_b16 a[66:67], v201 offset:51200
    v_mfma_f32_16x16x32_bf16 v[44:47], a[84:87], a[208:211], v[44:47]
    ds_read_b64_tr_b16 a[68:69], v200 offset:49152
    buffer_load_dwordx4 v221, s[60:63], s87 offen offset:2048 lds
    v_mfma_f32_16x16x32_bf16 v[48:51], a[84:87], a[212:215], v[48:51]
    ds_read_b64_tr_b16 a[70:71], v200 offset:51200
    s_waitcnt lgkmcnt(4)
    v_mfma_f32_16x16x32_bf16 v[36:39], a[88:91], a[216:219], v[36:39]
    ds_read_b64_tr_b16 a[72:73], v201 offset:53248
    v_mfma_f32_16x16x32_bf16 v[40:43], a[88:91], a[220:223], v[40:43]
    ds_read_b64_tr_b16 a[74:75], v201 offset:55296
    v_mfma_f32_16x16x32_bf16 v[44:47], a[92:95], a[216:219], v[44:47]
    ds_read_b64_tr_b16 a[76:77], v200 offset:53248
    buffer_load_dwordx4 v220, s[60:63], s87 offen offset:3072 lds
    v_mfma_f32_16x16x32_bf16 v[48:51], a[92:95], a[220:223], v[48:51]
    ds_read_b64_tr_b16 a[78:79], v200 offset:55296
    s_waitcnt lgkmcnt(4)
    v_mfma_f32_16x16x32_bf16 v[36:39], a[64:67], a[224:227], v[36:39]
    ds_read_b64_tr_b16 a[80:81], v201 offset:57344
    s_add_u32 m0, s76, 135168
    v_mfma_f32_16x16x32_bf16 v[40:43], a[64:67], a[228:231], v[40:43]
    ds_read_b64_tr_b16 a[82:83], v201 offset:59392
    s_xor_b32 s87, s32, 32768
    v_mfma_f32_16x16x32_bf16 v[44:47], a[68:71], a[224:227], v[44:47]
    ds_read_b64_tr_b16 a[84:85], v200 offset:57344
    buffer_load_dwordx4 v223, s[60:63], s87 offen lds
    v_mfma_f32_16x16x32_bf16 v[48:51], a[68:71], a[228:231], v[48:51]
    ds_read_b64_tr_b16 a[86:87], v200 offset:59392
    s_waitcnt lgkmcnt(4)
    v_mfma_f32_16x16x32_bf16 v[36:39], a[72:75], a[232:235], v[36:39]
    ds_read_b64_tr_b16 a[88:89], v201 offset:61440
    v_mfma_f32_16x16x32_bf16 v[40:43], a[72:75], a[236:239], v[40:43]
    ds_read_b64_tr_b16 a[90:91], v201 offset:63488
    v_mfma_f32_16x16x32_bf16 v[44:47], a[76:79], a[232:235], v[44:47]
    ds_read_b64_tr_b16 a[92:93], v200 offset:61440
    buffer_load_dwordx4 v222, s[60:63], s87 offen offset:1024 lds
    v_mfma_f32_16x16x32_bf16 v[48:51], a[76:79], a[236:239], v[48:51]
    ds_read_b64_tr_b16 a[94:95], v200 offset:63488
    s_waitcnt lgkmcnt(4)
    v_mfma_f32_16x16x32_bf16 v[36:39], a[80:83], a[240:243], v[36:39]
    ds_read_b64_tr_b16 a[64:65], v199 offset:0
    v_mfma_f32_16x16x32_bf16 v[40:43], a[80:83], a[244:247], v[40:43]
    ds_read_b64_tr_b16 a[66:67], v199 offset:2048
    v_mfma_f32_16x16x32_bf16 v[44:47], a[84:87], a[240:243], v[44:47]
    ds_read_b64_tr_b16 a[68:69], v198 offset:0
    buffer_load_dwordx4 v221, s[60:63], s87 offen offset:2048 lds
    v_mfma_f32_16x16x32_bf16 v[48:51], a[84:87], a[244:247], v[48:51]
    ds_read_b64_tr_b16 a[70:71], v198 offset:2048
    s_waitcnt lgkmcnt(4)
    v_mfma_f32_16x16x32_bf16 v[36:39], a[88:91], a[248:251], v[36:39]
    ds_read_b64_tr_b16 a[72:73], v199 offset:4096
    v_mfma_f32_16x16x32_bf16 v[40:43], a[88:91], a[252:255], v[40:43]
    ds_read_b64_tr_b16 a[74:75], v199 offset:6144
    v_mfma_f32_16x16x32_bf16 v[44:47], a[92:95], a[248:251], v[44:47]
    ds_read_b64_tr_b16 a[76:77], v198 offset:4096
    buffer_load_dwordx4 v220, s[60:63], s87 offen offset:3072 lds
    v_mfma_f32_16x16x32_bf16 v[48:51], a[92:95], a[252:255], v[48:51]
    ds_read_b64_tr_b16 a[78:79], v198 offset:6144
    s_waitcnt lgkmcnt(4)
    v_mfma_f32_16x16x32_bf16 v[52:55], a[64:67], a[128:131], 0
    ds_read_b64_tr_b16 a[80:81], v199 offset:8192
    v_mfma_f32_16x16x32_bf16 v[56:59], a[64:67], a[132:135], 0
    ds_read_b64_tr_b16 a[82:83], v199 offset:10240
    v_mfma_f32_16x16x32_bf16 v[60:63], a[68:71], a[128:131], 0
    ds_read_b64_tr_b16 a[84:85], v198 offset:8192
    buffer_load_dwordx4 v[76:79], v225, s[48:51], s22 offen sc1
    v_mfma_f32_16x16x32_bf16 v[64:67], a[68:71], a[132:135], 0
    ds_read_b64_tr_b16 a[86:87], v198 offset:10240
    s_waitcnt lgkmcnt(4)
    v_mfma_f32_16x16x32_bf16 v[52:55], a[72:75], a[136:139], v[52:55]
    ds_read_b64_tr_b16 a[88:89], v199 offset:12288
    v_mfma_f32_16x16x32_bf16 v[56:59], a[72:75], a[140:143], v[56:59]
    ds_read_b64_tr_b16 a[90:91], v199 offset:14336
    v_mfma_f32_16x16x32_bf16 v[60:63], a[76:79], a[136:139], v[60:63]
    ds_read_b64_tr_b16 a[92:93], v198 offset:12288
    buffer_load_dwordx4 v[80:83], v225, s[48:51], s22 offen offset:1024 sc1
    v_mfma_f32_16x16x32_bf16 v[64:67], a[76:79], a[140:143], v[64:67]
    ds_read_b64_tr_b16 a[94:95], v198 offset:14336
    s_waitcnt lgkmcnt(4)
    v_mfma_f32_16x16x32_bf16 v[52:55], a[80:83], a[144:147], v[52:55]
    ds_read_b64_tr_b16 a[64:65], v199 offset:16384
    v_pk_mul_f32 v[140:141], v[186:187], v[36:37] op_sel_hi:[0,1]
    v_pk_mul_f32 v[142:143], v[186:187], v[38:39] op_sel_hi:[0,1]
    v_pk_mul_f32 v[144:145], v[186:187], v[40:41] op_sel_hi:[0,1]
    v_pk_mul_f32 v[146:147], v[186:187], v[42:43] op_sel_hi:[0,1]
    v_mfma_f32_16x16x32_bf16 v[56:59], a[80:83], a[148:151], v[56:59]
    ds_read_b64_tr_b16 a[66:67], v199 offset:18432
    v_exp_f32 v140, v140 clamp
    v_mfma_f32_16x16x32_bf16 v[60:63], a[84:87], a[144:147], v[60:63]
    ds_read_b64_tr_b16 a[68:69], v198 offset:16384
    buffer_load_dwordx4 v[84:87], v225, s[48:51], s22 offen offset:2048 sc1
    v_mfma_f32_16x16x32_bf16 v[64:67], a[84:87], a[148:151], v[64:67]
    ds_read_b64_tr_b16 a[70:71], v198 offset:18432
    v_max_f32 v36, s17, v36
    s_waitcnt lgkmcnt(4)
    v_mfma_f32_16x16x32_bf16 v[52:55], a[88:91], a[152:155], v[52:55]
    ds_read_b64_tr_b16 a[72:73], v199 offset:20480
    v_exp_f32 v141, v141 clamp
    v_mfma_f32_16x16x32_bf16 v[56:59], a[88:91], a[156:159], v[56:59]
    ds_read_b64_tr_b16 a[74:75], v199 offset:22528
    v_max_f32 v37, s17, v37
    v_mfma_f32_16x16x32_bf16 v[60:63], a[92:95], a[152:155], v[60:63]
    ds_read_b64_tr_b16 a[76:77], v198 offset:20480
    buffer_load_dwordx4 v[88:91], v225, s[48:51], s22 offen offset:3072 sc1
    v_mfma_f32_16x16x32_bf16 v[64:67], a[92:95], a[156:159], v[64:67]
    ds_read_b64_tr_b16 a[78:79], v198 offset:22528
    v_exp_f32 v142, v142 clamp
    s_waitcnt lgkmcnt(4)
    v_mfma_f32_16x16x32_bf16 v[52:55], a[64:67], a[160:163], v[52:55]
    ds_read_b64_tr_b16 a[80:81], v199 offset:24576
    v_max_f32 v38, s17, v38
    v_mfma_f32_16x16x32_bf16 v[56:59], a[64:67], a[164:167], v[56:59]
    ds_read_b64_tr_b16 a[82:83], v199 offset:26624
    v_exp_f32 v143, v143 clamp
    v_mfma_f32_16x16x32_bf16 v[60:63], a[68:71], a[160:163], v[60:63]
    ds_read_b64_tr_b16 a[84:85], v198 offset:24576
    buffer_load_dwordx4 v[92:95], v225, s[48:51], s21 offen sc1
    v_mfma_f32_16x16x32_bf16 v[64:67], a[68:71], a[164:167], v[64:67]
    ds_read_b64_tr_b16 a[86:87], v198 offset:26624
    v_max_f32 v39, s17, v39
    s_waitcnt lgkmcnt(4)
    v_mfma_f32_16x16x32_bf16 v[52:55], a[72:75], a[168:171], v[52:55]
    ds_read_b64_tr_b16 a[88:89], v199 offset:28672
    v_exp_f32 v144, v144 clamp
    v_mfma_f32_16x16x32_bf16 v[56:59], a[72:75], a[172:175], v[56:59]
    ds_read_b64_tr_b16 a[90:91], v199 offset:30720
    v_max_f32 v40, s17, v40
    v_mfma_f32_16x16x32_bf16 v[60:63], a[76:79], a[168:171], v[60:63]
    ds_read_b64_tr_b16 a[92:93], v198 offset:28672
    buffer_load_dwordx4 v[96:99], v225, s[48:51], s21 offen offset:1024 sc1
    v_mfma_f32_16x16x32_bf16 v[64:67], a[76:79], a[172:175], v[64:67]
    ds_read_b64_tr_b16 a[94:95], v198 offset:30720
    v_exp_f32 v145, v145 clamp
    s_waitcnt lgkmcnt(4)
    v_mfma_f32_16x16x32_bf16 v[52:55], a[80:83], a[176:179], v[52:55]
    ds_read_b64_tr_b16 a[64:65], v199 offset:32768
    v_max_f32 v41, s17, v41
    v_mfma_f32_16x16x32_bf16 v[56:59], a[80:83], a[180:183], v[56:59]
    ds_read_b64_tr_b16 a[66:67], v199 offset:34816
    v_exp_f32 v146, v146 clamp
    v_mfma_f32_16x16x32_bf16 v[60:63], a[84:87], a[176:179], v[60:63]
    ds_read_b64_tr_b16 a[68:69], v198 offset:32768
    buffer_load_dwordx4 v[100:103], v225, s[48:51], s21 offen offset:2048 sc1
    v_mfma_f32_16x16x32_bf16 v[64:67], a[84:87], a[180:183], v[64:67]
    ds_read_b64_tr_b16 a[70:71], v198 offset:34816
    v_max_f32 v42, s17, v42
    s_waitcnt lgkmcnt(4)
    v_mfma_f32_16x16x32_bf16 v[52:55], a[88:91], a[184:187], v[52:55]
    ds_read_b64_tr_b16 a[72:73], v199 offset:36864
    v_exp_f32 v147, v147 clamp
    v_mfma_f32_16x16x32_bf16 v[56:59], a[88:91], a[188:191], v[56:59]
    ds_read_b64_tr_b16 a[74:75], v199 offset:38912
    v_max_f32 v43, s17, v43
    v_mfma_f32_16x16x32_bf16 v[60:63], a[92:95], a[184:187], v[60:63]
    ds_read_b64_tr_b16 a[76:77], v198 offset:36864
    buffer_load_dwordx4 v[104:107], v225, s[48:51], s21 offen offset:3072 sc1
    v_pk_add_f32 v[36:37], v[36:37], v[140:141]
    v_pk_add_f32 v[38:39], v[38:39], v[142:143]
    v_pk_add_f32 v[40:41], v[40:41], v[144:145]
    v_pk_add_f32 v[42:43], v[42:43], v[146:147]
    v_mfma_f32_16x16x32_bf16 v[64:67], a[92:95], a[188:191], v[64:67]
    ds_read_b64_tr_b16 a[78:79], v198 offset:38912
    v_cvt_pk_bf16_f32 v148, v36, v37
    s_waitcnt lgkmcnt(4)
    v_mfma_f32_16x16x32_bf16 v[52:55], a[64:67], a[192:195], v[52:55]
    ds_read_b64_tr_b16 a[80:81], v199 offset:40960
    v_cvt_pk_bf16_f32 v149, v38, v39
    v_mfma_f32_16x16x32_bf16 v[56:59], a[64:67], a[196:199], v[56:59]
    ds_read_b64_tr_b16 a[82:83], v199 offset:43008
    v_cvt_pk_bf16_f32 v150, v40, v41
    v_mfma_f32_16x16x32_bf16 v[60:63], a[68:71], a[192:195], v[60:63]
    ds_read_b64_tr_b16 a[84:85], v198 offset:40960
    buffer_load_dwordx4 v[108:111], v225, s[48:51], s20 offen sc1
    v_mfma_f32_16x16x32_bf16 v[64:67], a[68:71], a[196:199], v[64:67]
    ds_read_b64_tr_b16 a[86:87], v198 offset:43008
    v_cvt_pk_bf16_f32 v151, v42, v43
    s_waitcnt lgkmcnt(4)
    v_mfma_f32_16x16x32_bf16 v[52:55], a[72:75], a[200:203], v[52:55]
    ds_read_b64_tr_b16 a[88:89], v199 offset:45056
    v_pk_mul_f32 v[140:141], v[186:187], v[44:45] op_sel_hi:[0,1]
    v_pk_mul_f32 v[142:143], v[186:187], v[46:47] op_sel_hi:[0,1]
    v_pk_mul_f32 v[144:145], v[186:187], v[48:49] op_sel_hi:[0,1]
    v_pk_mul_f32 v[146:147], v[186:187], v[50:51] op_sel_hi:[0,1]
    v_mfma_f32_16x16x32_bf16 v[56:59], a[72:75], a[204:207], v[56:59]
    ds_read_b64_tr_b16 a[90:91], v199 offset:47104
    v_exp_f32 v140, v140 clamp
    v_mfma_f32_16x16x32_bf16 v[60:63], a[76:79], a[200:203], v[60:63]
    ds_read_b64_tr_b16 a[92:93], v198 offset:45056
    buffer_load_dwordx4 v[112:115], v225, s[48:51], s20 offen offset:1024 sc1
    v_mfma_f32_16x16x32_bf16 v[64:67], a[76:79], a[204:207], v[64:67]
    ds_read_b64_tr_b16 a[94:95], v198 offset:47104
    v_max_f32 v44, s17, v44
    s_waitcnt lgkmcnt(4)
    v_mfma_f32_16x16x32_bf16 v[52:55], a[80:83], a[208:211], v[52:55]
    ds_read_b64_tr_b16 a[64:65], v199 offset:49152
    v_exp_f32 v141, v141 clamp
    v_mfma_f32_16x16x32_bf16 v[56:59], a[80:83], a[212:215], v[56:59]
    ds_read_b64_tr_b16 a[66:67], v199 offset:51200
    v_max_f32 v45, s17, v45
    v_mfma_f32_16x16x32_bf16 v[60:63], a[84:87], a[208:211], v[60:63]
    ds_read_b64_tr_b16 a[68:69], v198 offset:49152
    buffer_load_dwordx4 v[116:119], v225, s[48:51], s20 offen offset:2048 sc1
    v_mfma_f32_16x16x32_bf16 v[64:67], a[84:87], a[212:215], v[64:67]
    ds_read_b64_tr_b16 a[70:71], v198 offset:51200
    v_exp_f32 v142, v142 clamp
    s_waitcnt lgkmcnt(4)
    v_mfma_f32_16x16x32_bf16 v[52:55], a[88:91], a[216:219], v[52:55]
    ds_read_b64_tr_b16 a[72:73], v199 offset:53248
    v_max_f32 v46, s17, v46
    v_mfma_f32_16x16x32_bf16 v[56:59], a[88:91], a[220:223], v[56:59]
    ds_read_b64_tr_b16 a[74:75], v199 offset:55296
    v_exp_f32 v143, v143 clamp
    v_mfma_f32_16x16x32_bf16 v[60:63], a[92:95], a[216:219], v[60:63]
    ds_read_b64_tr_b16 a[76:77], v198 offset:53248
    buffer_load_dwordx4 v[120:123], v225, s[48:51], s20 offen offset:3072 sc1
    v_mfma_f32_16x16x32_bf16 v[64:67], a[92:95], a[220:223], v[64:67]
    ds_read_b64_tr_b16 a[78:79], v198 offset:55296
    v_max_f32 v47, s17, v47
    s_waitcnt lgkmcnt(4)
    v_mfma_f32_16x16x32_bf16 v[52:55], a[64:67], a[224:227], v[52:55]
    ds_read_b64_tr_b16 a[80:81], v199 offset:57344
    v_exp_f32 v144, v144 clamp
    v_mfma_f32_16x16x32_bf16 v[56:59], a[64:67], a[228:231], v[56:59]
    ds_read_b64_tr_b16 a[82:83], v199 offset:59392
    v_max_f32 v48, s17, v48
    v_mfma_f32_16x16x32_bf16 v[60:63], a[68:71], a[224:227], v[60:63]
    ds_read_b64_tr_b16 a[84:85], v198 offset:57344
    buffer_load_dwordx4 v[124:127], v225, s[48:51], s19 offen sc1
    v_mfma_f32_16x16x32_bf16 v[64:67], a[68:71], a[228:231], v[64:67]
    ds_read_b64_tr_b16 a[86:87], v198 offset:59392
    v_exp_f32 v145, v145 clamp
    s_waitcnt lgkmcnt(4)
    v_mfma_f32_16x16x32_bf16 v[52:55], a[72:75], a[232:235], v[52:55]
    ds_read_b64_tr_b16 a[88:89], v199 offset:61440
    v_max_f32 v49, s17, v49
    v_mfma_f32_16x16x32_bf16 v[56:59], a[72:75], a[236:239], v[56:59]
    ds_read_b64_tr_b16 a[90:91], v199 offset:63488
    v_exp_f32 v146, v146 clamp
    v_mfma_f32_16x16x32_bf16 v[60:63], a[76:79], a[232:235], v[60:63]
    ds_read_b64_tr_b16 a[92:93], v198 offset:61440
    buffer_load_dwordx4 v[128:131], v225, s[48:51], s19 offen offset:1024 sc1
    v_mfma_f32_16x16x32_bf16 v[64:67], a[76:79], a[236:239], v[64:67]
    ds_read_b64_tr_b16 a[94:95], v198 offset:63488
    v_max_f32 v50, s17, v50
    s_waitcnt lgkmcnt(4)
    v_mfma_f32_16x16x32_bf16 v[52:55], a[80:83], a[240:243], v[52:55]
    v_exp_f32 v147, v147 clamp
    v_mfma_f32_16x16x32_bf16 v[56:59], a[80:83], a[244:247], v[56:59]
    v_max_f32 v51, s17, v51
    v_mfma_f32_16x16x32_bf16 v[60:63], a[84:87], a[240:243], v[60:63]
    buffer_load_dwordx4 v[132:135], v225, s[48:51], s19 offen offset:2048 sc1
    v_pk_add_f32 v[44:45], v[44:45], v[140:141]
    v_pk_add_f32 v[46:47], v[46:47], v[142:143]
    v_pk_add_f32 v[48:49], v[48:49], v[144:145]
    v_pk_add_f32 v[50:51], v[50:51], v[146:147]
    v_mfma_f32_16x16x32_bf16 v[64:67], a[84:87], a[244:247], v[64:67]
    v_cvt_pk_bf16_f32 v152, v44, v45
    s_waitcnt lgkmcnt(0)
    v_mfma_f32_16x16x32_bf16 v[52:55], a[88:91], a[248:251], v[52:55]
    v_cvt_pk_bf16_f32 v153, v46, v47
    v_mfma_f32_16x16x32_bf16 v[56:59], a[88:91], a[252:255], v[56:59]
    v_cvt_pk_bf16_f32 v154, v48, v49
    v_mfma_f32_16x16x32_bf16 v[60:63], a[92:95], a[248:251], v[60:63]
    buffer_load_dwordx4 v[136:139], v225, s[48:51], s19 offen offset:3072 sc1
    v_cvt_pk_bf16_f32 v155, v50, v51
    v_mfma_f32_16x16x32_bf16 v[64:67], a[92:95], a[252:255], v[64:67]
    s_barrier
L_gchk_att:
    v_xor_b32 v255, v25, v240
    v_bitop3_b32 v255, v255, v27, v240 bitop3:0xf6
    v_bitop3_b32 v255, v255, v69, v240 bitop3:0xf6
    v_bitop3_b32 v255, v255, v71, v240 bitop3:0xf6
    v_cmp_ne_u32 vcc, 0, v255
    s_sub_u32 s72, s72, 1
    s_cselect_b64 vcc, 0, vcc
    s_cselect_b32 s72, 0, s72
    s_cmp_lg_u64 vcc, 0
    s_cbranch_scc0 L_gok_att
    buffer_load_dwordx4 v[68:71], v231, s[48:51], 0 offen sc1
L_pg3574:
    s_cbranch_execz L_backa
    buffer_load_dwordx4 v[24:27], v230, s[48:51], 0 offen sc1
    s_waitcnt vmcnt(0)
    s_branch L_gchk_att
L_gok_att:
    v_pk_mul_f32 v[140:141], v[186:187], v[52:53] op_sel_hi:[0,1]
    s_xor_b32 m0, s75, 65536
    s_xor_b32 s87, s33, 0
    buffer_load_dwordx4 v219, s[52:55], s87 offen lds
    v_pk_mul_f32 v[142:143], v[186:187], v[54:55] op_sel_hi:[0,1]
    v_pk_mul_f32 v[144:145], v[186:187], v[56:57] op_sel_hi:[0,1]
    v_pk_mul_f32 v[146:147], v[186:187], v[58:59] op_sel_hi:[0,1]
    buffer_load_dwordx4 v218, s[52:55], s87 offen offset:2048 lds
    v_exp_f32 v140, v140 clamp
    v_max_f32 v52, s17, v52
    v_exp_f32 v141, v141 clamp
    v_max_f32 v53, s17, v53
    s_xor_b32 m0, s75, 73728
    s_xor_b32 s87, s33, 128
    buffer_load_dwordx4 v219, s[52:55], s87 offen lds
    v_exp_f32 v142, v142 clamp
    v_max_f32 v54, s17, v54
    v_exp_f32 v143, v143 clamp
    buffer_load_dwordx4 v218, s[52:55], s87 offen offset:2048 lds
    v_max_f32 v55, s17, v55
    v_exp_f32 v144, v144 clamp
    v_max_f32 v56, s17, v56
    v_exp_f32 v145, v145 clamp
    s_xor_b32 m0, s75, 81920
    s_xor_b32 s87, s33, 256
    buffer_load_dwordx4 v219, s[52:55], s87 offen lds
    v_max_f32 v57, s17, v57
    v_exp_f32 v146, v146 clamp
    v_max_f32 v58, s17, v58
    buffer_load_dwordx4 v218, s[52:55], s87 offen offset:2048 lds
    v_exp_f32 v147, v147 clamp
    v_max_f32 v59, s17, v59
    v_pk_add_f32 v[52:53], v[52:53], v[140:141]
    v_pk_add_f32 v[54:55], v[54:55], v[142:143]
    s_xor_b32 m0, s75, 90112
    s_xor_b32 s87, s33, 384
    buffer_load_dwordx4 v219, s[52:55], s87 offen lds
    v_pk_add_f32 v[56:57], v[56:57], v[144:145]
    v_pk_add_f32 v[58:59], v[58:59], v[146:147]
    v_cvt_pk_bf16_f32 v156, v52, v53
    buffer_load_dwordx4 v218, s[52:55], s87 offen offset:2048 lds
    v_cvt_pk_bf16_f32 v157, v54, v55
    v_cvt_pk_bf16_f32 v158, v56, v57
    v_cvt_pk_bf16_f32 v159, v58, v59
    v_mov_b32 v234, 0
    v_mov_b32 v235, 0
    v_mov_b32 v236, 0
    v_mov_b32 v237, 0
    v_mov_b32 v238, 0
    v_mov_b32 v72, s17
    s_waitcnt vmcnt(20)
L_kchk0:
    v_xor_b32 v255, v79, v240
    v_bitop3_b32 v255, v255, v83, v240 bitop3:0xf6
    v_bitop3_b32 v255, v255, v87, v240 bitop3:0xf6
    v_bitop3_b32 v255, v255, v91, v240 bitop3:0xf6
    v_cmp_ne_u32 vcc, 0, v255
    s_cmp_lg_u64 vcc, 0
    s_cbranch_scc1 L_kre0
L_kgo0:
    v_dot2c_f32_bf16 v234, v76, v190
    v_dot2c_f32_bf16 v235, v76, v189
    v_dot2c_f32_bf16 v236, v77, v190
    v_dot2c_f32_bf16 v237, v77, v189
    v_add_f32 v238, v238, v78
    v_dot2c_f32_bf16 v234, v80, v190
    v_dot2c_f32_bf16 v235, v80, v189
    v_dot2c_f32_bf16 v236, v81, v190
    v_dot2c_f32_bf16 v237, v81, v189
    v_add_f32 v238, v238, v82
    v_dot2c_f32_bf16 v234, v84, v190
    v_dot2c_f32_bf16 v235, v84, v189
    v_dot2c_f32_bf16 v236, v85, v190
    v_dot2c_f32_bf16 v237, v85, v189
    v_add_f32 v238, v238, v86
    v_dot2c_f32_bf16 v234, v88, v190
    v_dot2c_f32_bf16 v235, v88, v189
    v_dot2c_f32_bf16 v236, v89, v190
    v_dot2c_f32_bf16 v237, v89, v189
    v_add_f32 v238, v238, v90
    s_waitcnt vmcnt(16)
L_kchk1:
    v_xor_b32 v255, v95, v240
    v_bitop3_b32 v255, v255, v99, v240 bitop3:0xf6
    v_bitop3_b32 v255, v255, v103, v240 bitop3:0xf6
    v_bitop3_b32 v255, v255, v107, v240 bitop3:0xf6
    v_cmp_ne_u32 vcc, 0, v255
    s_cmp_lg_u64 vcc, 0
    s_cbranch_scc1 L_kre1
L_kgo1:
    v_dot2c_f32_bf16 v234, v92, v190
    v_dot2c_f32_bf16 v235, v92, v189
    v_dot2c_f32_bf16 v236, v93, v190
    v_dot2c_f32_bf16 v237, v93, v189
    v_add_f32 v238, v238, v94
    v_dot2c_f32_bf16 v234, v96, v190
    v_dot2c_f32_bf16 v235, v96, v189
    v_dot2c_f32_bf16 v236, v97, v190
    v_dot2c_f32_bf16 v237, v97, v189
    v_add_f32 v238, v238, v98
    v_dot2c_f32_bf16 v234, v100, v190
    v_dot2c_f32_bf16 v235, v100, v189
    v_dot2c_f32_bf16 v236, v101, v190
    v_dot2c_f32_bf16 v237, v101, v189
    v_add_f32 v238, v238, v102
    v_dot2c_f32_bf16 v234, v104, v190
    v_dot2c_f32_bf16 v235, v104, v189
    v_dot2c_f32_bf16 v236, v105, v190
    v_dot2c_f32_bf16 v237, v105, v189
    v_add_f32 v238, v238, v106
    s_waitcnt vmcnt(12)
L_kchk2:
    v_xor_b32 v255, v111, v240
    v_bitop3_b32 v255, v255, v115, v240 bitop3:0xf6
    v_bitop3_b32 v255, v255, v119, v240 bitop3:0xf6
    v_bitop3_b32 v255, v255, v123, v240 bitop3:0xf6
    v_cmp_ne_u32 vcc, 0, v255
    s_cmp_lg_u64 vcc, 0
    s_cbranch_scc1 L_kre2
L_kgo2:
    v_dot2c_f32_bf16 v234, v108, v190
    v_dot2c_f32_bf16 v235, v108, v189
    v_dot2c_f32_bf16 v236, v109, v190
    v_dot2c_f32_bf16 v237, v109, v189
    v_add_f32 v238, v238, v110
    v_dot2c_f32_bf16 v234, v112, v190
    v_dot2c_f32_bf16 v235, v112, v189
    v_dot2c_f32_bf16 v236, v113, v190
    v_dot2c_f32_bf16 v237, v113, v189
    v_add_f32 v238, v238, v114
    v_dot2c_f32_bf16 v234, v116, v190
    v_dot2c_f32_bf16 v235, v116, v189
    v_dot2c_f32_bf16 v236, v117, v190
    v_dot2c_f32_bf16 v237, v117, v189
    v_add_f32 v238, v238, v118
    v_dot2c_f32_bf16 v234, v120, v190
    v_dot2c_f32_bf16 v235, v120, v189
    v_dot2c_f32_bf16 v236, v121, v190
    v_dot2c_f32_bf16 v237, v121, v189
    v_add_f32 v238, v238, v122
    s_waitcnt vmcnt(8)
L_kchk3:
    v_xor_b32 v255, v127, v240
    v_bitop3_b32 v255, v255, v131, v240 bitop3:0xf6
    v_bitop3_b32 v255, v255, v135, v240 bitop3:0xf6
    v_bitop3_b32 v255, v255, v139, v240 bitop3:0xf6
    v_cmp_ne_u32 vcc, 0, v255
    s_cmp_lg_u64 vcc, 0
    s_cbranch_scc1 L_kre3
L_kgo3:
    v_dot2c_f32_bf16 v234, v124, v190
    v_dot2c_f32_bf16 v235, v124, v189
    v_dot2c_f32_bf16 v236, v125, v190
    v_dot2c_f32_bf16 v237, v125, v189
    v_add_f32 v238, v238, v126
    v_dot2c_f32_bf16 v234, v128, v190
    v_dot2c_f32_bf16 v235, v128, v189
    v_dot2c_f32_bf16 v236, v129, v190
    v_dot2c_f32_bf16 v237, v129, v189
    v_add_f32 v238, v238, v130
    v_dot2c_f32_bf16 v234, v132, v190
    v_dot2c_f32_bf16 v235, v132, v189
    v_dot2c_f32_bf16 v236, v133, v190
    v_dot2c_f32_bf16 v237, v133, v189
    v_add_f32 v238, v238, v134
    v_dot2c_f32_bf16 v234, v136, v190
    v_dot2c_f32_bf16 v235, v136, v189
    v_dot2c_f32_bf16 v236, v137, v190
    v_dot2c_f32_bf16 v237, v137, v189
    v_add_f32 v238, v238, v138
    v_cvt_pk_bf16_f32 v234, v234, v235
    s_nop 0
    v_cvt_pk_bf16_f32 v235, v236, v237
    v_cvt_pk_bf16_f32 v238, v238, v238
    ds_write_b64 v188, v[234:235]
    ds_write_b16 v185, v238
    v_pk_mul_f32 v[140:141], v[186:187], v[60:61] op_sel_hi:[0,1]
    v_pk_mul_f32 v[142:143], v[186:187], v[62:63] op_sel_hi:[0,1]
    v_pk_mul_f32 v[144:145], v[186:187], v[64:65] op_sel_hi:[0,1]
    v_pk_mul_f32 v[146:147], v[186:187], v[66:67] op_sel_hi:[0,1]
    v_exp_f32 v140, v140 clamp
    v_max_f32 v60, s17, v60
    v_exp_f32 v141, v141 clamp
    v_max_f32 v61, s17, v61
    v_exp_f32 v142, v142 clamp
    v_max_f32 v62, s17, v62
    v_exp_f32 v143, v143 clamp
    v_max_f32 v63, s17, v63
    s_waitcnt lgkmcnt(0)
    s_barrier
    ds_read_b64 v[172:173], v183 offset:0
    ds_read_b64 v[164:165], v184 offset:0
    ds_read_b64 v[174:175], v183 offset:512
    ds_read_b64 v[166:167], v184 offset:512
    ds_read_b64 v[176:177], v183 offset:1024
    ds_read_b64 v[168:169], v184 offset:1024
    ds_read_b64 v[178:179], v183 offset:1536
    ds_read_b64 v[170:171], v184 offset:1536
    v_exp_f32 v144, v144 clamp
    s_xor_b32 m0, s75, 98304
    s_xor_b32 s87, s33, 512
    buffer_load_dwordx4 v219, s[52:55], s87 offen lds
    v_max_f32 v64, s17, v64
    v_exp_f32 v145, v145 clamp
    buffer_load_dwordx4 v218, s[52:55], s87 offen offset:2048 lds
    v_max_f32 v65, s17, v65
    v_exp_f32 v146, v146 clamp
    v_max_f32 v66, s17, v66
    s_xor_b32 m0, s75, 106496
    s_xor_b32 s87, s33, 640
    buffer_load_dwordx4 v219, s[52:55], s87 offen lds
    v_exp_f32 v147, v147 clamp
    v_max_f32 v67, s17, v67
    v_pk_add_f32 v[60:61], v[60:61], v[140:141]
    buffer_load_dwordx4 v218, s[52:55], s87 offen offset:2048 lds
    v_pk_add_f32 v[62:63], v[62:63], v[142:143]
    v_pk_add_f32 v[64:65], v[64:65], v[144:145]
    s_xor_b32 m0, s75, 114688
    s_xor_b32 s87, s33, 768
    buffer_load_dwordx4 v219, s[52:55], s87 offen lds
    v_pk_add_f32 v[66:67], v[66:67], v[146:147]
    v_cvt_pk_bf16_f32 v160, v60, v61
    v_cvt_pk_bf16_f32 v161, v62, v63
    buffer_load_dwordx4 v218, s[52:55], s87 offen offset:2048 lds
    v_cvt_pk_bf16_f32 v162, v64, v65
    v_cvt_pk_bf16_f32 v163, v66, v67
    s_waitcnt lgkmcnt(4)
    v_mfma_f32_16x16x16_bf16 v[76:79], v[172:173], v[148:149], v[72:75]
    v_mfma_f32_16x16x16_bf16 v[80:83], v[174:175], v[152:153], v[72:75]
    v_mfma_f32_16x16x16_bf16 v[84:87], v[164:165], v[148:149], 0
    v_mfma_f32_16x16x16_bf16 v[88:91], v[166:167], v[152:153], 0
    v_mfma_f32_16x16x16_bf16 v[92:95], v[172:173], v[150:151], v[72:75]
    v_mfma_f32_16x16x16_bf16 v[96:99], v[174:175], v[154:155], v[72:75]
    v_mfma_f32_16x16x16_bf16 v[100:103], v[164:165], v[150:151], 0
    v_mfma_f32_16x16x16_bf16 v[104:107], v[166:167], v[154:155], 0
    s_waitcnt lgkmcnt(0)
    v_mfma_f32_16x16x16_bf16 v[108:111], v[176:177], v[156:157], v[72:75]
    v_rcp_f32 v76, v76
    v_mfma_f32_16x16x16_bf16 v[112:115], v[178:179], v[160:161], v[72:75]
    v_rcp_f32 v80, v80
    v_mul_f32 v76, v76, v68
    v_mul_f32 v80, v80, v68
    v_pk_mul_f32 v[84:85], v[76:77], v[84:85] op_sel_hi:[0,1]
    v_pk_mul_f32 v[86:87], v[76:77], v[86:87] op_sel_hi:[0,1]
    v_pk_mul_f32 v[88:89], v[80:81], v[88:89] op_sel_hi:[0,1]
    v_pk_mul_f32 v[90:91], v[80:81], v[90:91] op_sel_hi:[0,1]
    v_mfma_f32_16x16x16_bf16 v[116:119], v[168:169], v[156:157], 0
    v_cvt_pk_bf16_f32 v76, v84, v85
    v_cvt_pk_bf16_f32 v77, v86, v87
    v_mfma_f32_16x16x16_bf16 v[120:123], v[170:171], v[160:161], 0
    v_cvt_pk_bf16_f32 v78, v88, v89
    v_cvt_pk_bf16_f32 v79, v90, v91
    buffer_store_dwordx4 v[76:79], v225, s[48:51], s18 offen sc1
    v_mfma_f32_16x16x16_bf16 v[124:127], v[176:177], v[158:159], v[72:75]
    v_rcp_f32 v92, v92
    v_mfma_f32_16x16x16_bf16 v[128:131], v[178:179], v[162:163], v[72:75]
    v_rcp_f32 v96, v96
    v_mul_f32 v92, v92, v70
    v_mul_f32 v96, v96, v70
    v_pk_mul_f32 v[100:101], v[92:93], v[100:101] op_sel_hi:[0,1]
    v_pk_mul_f32 v[102:103], v[92:93], v[102:103] op_sel_hi:[0,1]
    v_pk_mul_f32 v[104:105], v[96:97], v[104:105] op_sel_hi:[0,1]
    v_pk_mul_f32 v[106:107], v[96:97], v[106:107] op_sel_hi:[0,1]
    v_mfma_f32_16x16x16_bf16 v[132:135], v[168:169], v[158:159], 0
    v_cvt_pk_bf16_f32 v92, v100, v101
    v_cvt_pk_bf16_f32 v93, v102, v103
    v_mfma_f32_16x16x16_bf16 v[136:139], v[170:171], v[162:163], 0
    v_cvt_pk_bf16_f32 v94, v104, v105
    v_cvt_pk_bf16_f32 v95, v106, v107
    buffer_store_dwordx4 v[92:95], v225, s[48:51], s18 offen offset:1024 sc1
    v_rcp_f32 v108, v108
    v_rcp_f32 v112, v112
    v_mul_f32 v108, v108, v68
    v_mul_f32 v112, v112, v68
    v_pk_mul_f32 v[116:117], v[108:109], v[116:117] op_sel_hi:[0,1]
    v_pk_mul_f32 v[118:119], v[108:109], v[118:119] op_sel_hi:[0,1]
    v_pk_mul_f32 v[120:121], v[112:113], v[120:121] op_sel_hi:[0,1]
    v_pk_mul_f32 v[122:123], v[112:113], v[122:123] op_sel_hi:[0,1]
    v_cvt_pk_bf16_f32 v108, v116, v117
    v_cvt_pk_bf16_f32 v109, v118, v119
    v_cvt_pk_bf16_f32 v110, v120, v121
    v_cvt_pk_bf16_f32 v111, v122, v123
    buffer_store_dwordx4 v[108:111], v225, s[48:51], s18 offen offset:2048 sc1
    v_rcp_f32 v124, v124
    v_rcp_f32 v128, v128
    v_mul_f32 v124, v124, v70
    v_mul_f32 v128, v128, v70
    v_pk_mul_f32 v[132:133], v[124:125], v[132:133] op_sel_hi:[0,1]
    v_pk_mul_f32 v[134:135], v[124:125], v[134:135] op_sel_hi:[0,1]
    v_pk_mul_f32 v[136:137], v[128:129], v[136:137] op_sel_hi:[0,1]
    v_pk_mul_f32 v[138:139], v[128:129], v[138:139] op_sel_hi:[0,1]
    v_cvt_pk_bf16_f32 v124, v132, v133
    v_cvt_pk_bf16_f32 v125, v134, v135
    v_cvt_pk_bf16_f32 v126, v136, v137
    v_cvt_pk_bf16_f32 v127, v138, v139
    buffer_store_dwordx4 v[124:127], v225, s[48:51], s18 offen offset:3072 sc1
    v_sub_f32 v108, 1.0, v24
    ds_read_b64_tr_b16 a[0:1], v217 offset:0
    v_sub_f32 v109, 1.0, v26
    ds_read_b64_tr_b16 a[2:3], v217 offset:2048
    v_and_b32 v100, 0xffff, v2
    ds_read_b64_tr_b16 a[4:5], v216 offset:0
    v_and_b32 v101, 0xffff0000, v2
    ds_read_b64_tr_b16 a[6:7], v216 offset:2048
    v_and_b32 v102, 0xffff, v3
    ds_read_b64_tr_b16 a[8:9], v215 offset:0
    v_and_b32 v103, 0xffff0000, v3
    ds_read_b64_tr_b16 a[10:11], v215 offset:2048
    v_and_b32 v104, 0xffff, v4
    ds_read_b64_tr_b16 a[12:13], v214 offset:0
    v_and_b32 v105, 0xffff0000, v4
    ds_read_b64_tr_b16 a[14:15], v214 offset:2048
    v_and_b32 v106, 0xffff, v5
    v_and_b32 v107, 0xffff0000, v5
    ds_read_b64_tr_b16 a[16:17], v217 offset:4096
    v_cvt_pk_bf16_f32 v108, 0, v108
    ds_read_b64_tr_b16 a[18:19], v217 offset:6144
    v_cvt_pk_bf16_f32 v109, 0, v109
    ds_read_b64_tr_b16 a[20:21], v216 offset:4096
    v_dot2_f32_bf16 v8, v28, v100, 0
    ds_read_b64_tr_b16 a[22:23], v216 offset:6144
    v_dot2_f32_bf16 v9, v28, v101, 0
    ds_read_b64_tr_b16 a[24:25], v215 offset:4096
    v_dot2_f32_bf16 v10, v29, v102, 0
    ds_read_b64_tr_b16 a[26:27], v215 offset:6144
    v_dot2_f32_bf16 v11, v29, v103, 0
    ds_read_b64_tr_b16 a[28:29], v214 offset:4096
    v_dot2_f32_bf16 v12, v30, v104, 0
    ds_read_b64_tr_b16 a[30:31], v214 offset:6144
    v_dot2_f32_bf16 v13, v30, v105, 0
    v_dot2_f32_bf16 v14, v31, v106, 0
    ds_read_b64_tr_b16 a[32:33], v217 offset:8192
    v_dot2_f32_bf16 v15, v31, v107, 0
    ds_read_b64_tr_b16 a[34:35], v217 offset:10240
    v_dot2_f32_bf16 v16, v32, v100, 0
    ds_read_b64_tr_b16 a[36:37], v216 offset:8192
    v_dot2_f32_bf16 v17, v32, v101, 0
    ds_read_b64_tr_b16 a[38:39], v216 offset:10240
    v_dot2_f32_bf16 v18, v33, v102, 0
    ds_read_b64_tr_b16 a[40:41], v215 offset:8192
    v_dot2_f32_bf16 v19, v33, v103, 0
    ds_read_b64_tr_b16 a[42:43], v215 offset:10240
    v_dot2_f32_bf16 v20, v34, v104, 0
    ds_read_b64_tr_b16 a[44:45], v214 offset:8192
    v_dot2_f32_bf16 v21, v34, v105, 0
    ds_read_b64_tr_b16 a[46:47], v214 offset:10240
    v_dot2_f32_bf16 v22, v35, v106, 0
    v_dot2_f32_bf16 v23, v35, v107, 0
    ds_read_b64_tr_b16 a[48:49], v217 offset:12288
    v_pk_mul_f32 v[8:9], v[108:109], v[8:9] op_sel_hi:[0,1]
    ds_read_b64_tr_b16 a[50:51], v217 offset:14336
    v_pk_mul_f32 v[10:11], v[108:109], v[10:11] op_sel_hi:[0,1]
    ds_read_b64_tr_b16 a[52:53], v216 offset:12288
    v_pk_mul_f32 v[12:13], v[108:109], v[12:13] op_sel_hi:[0,1]
    ds_read_b64_tr_b16 a[54:55], v216 offset:14336
    v_pk_mul_f32 v[14:15], v[108:109], v[14:15] op_sel_hi:[0,1]
    ds_read_b64_tr_b16 a[56:57], v215 offset:12288
    v_pk_mul_f32 v[16:17], v[108:109], v[16:17] op_sel:[1,0]
    ds_read_b64_tr_b16 a[58:59], v215 offset:14336
    v_pk_mul_f32 v[18:19], v[108:109], v[18:19] op_sel:[1,0]
    ds_read_b64_tr_b16 a[60:61], v214 offset:12288
    v_pk_mul_f32 v[20:21], v[108:109], v[20:21] op_sel:[1,0]
    ds_read_b64_tr_b16 a[62:63], v214 offset:14336
    v_pk_mul_f32 v[22:23], v[108:109], v[22:23] op_sel:[1,0]
    s_waitcnt lgkmcnt(0)
    s_barrier
    s_xor_b32 m0, s75, 122880
    s_xor_b32 s87, s33, 896
    buffer_load_dwordx4 v219, s[52:55], s87 offen lds
    buffer_load_dwordx4 v218, s[52:55], s87 offen offset:2048 lds
    s_add_u32 m0, s76, 131072
    s_xor_b32 s87, s32, 131072
    buffer_load_dwordx4 v223, s[60:63], s87 offen lds
    buffer_load_dwordx4 v222, s[60:63], s87 offen offset:1024 lds
    buffer_load_dwordx4 v221, s[60:63], s87 offen offset:2048 lds
    buffer_load_dwordx4 v220, s[60:63], s87 offen offset:3072 lds
    s_add_u32 m0, s76, 135168
    s_xor_b32 s87, s32, 163840
    buffer_load_dwordx4 v223, s[60:63], s87 offen lds
    buffer_load_dwordx4 v222, s[60:63], s87 offen offset:1024 lds
    buffer_load_dwordx4 v221, s[60:63], s87 offen offset:2048 lds
    buffer_load_dwordx4 v220, s[60:63], s87 offen offset:3072 lds
    ds_read_b128 v[68:71], v213 offset:0
    ds_read_b128 v[72:75], v213 offset:2048
    ds_read_b128 v[76:79], v211 offset:0
    ds_read_b128 v[80:83], v211 offset:2048
    ds_read_b128 v[84:87], v212 offset:0
    ds_read_b128 v[88:91], v212 offset:2048
    buffer_load_dword v253, v229, s[48:51], s29 offen sc1
    s_waitcnt vmcnt(11)
    buffer_store_dword v240, v232, s[48:51], 0 offen sc1
    s_waitcnt vmcnt(1)
    s_branch L_hchka
L_kre0:
    s_sub_u32 s72, s72, 1
    s_cselect_b64 vcc, 0, vcc
    s_cselect_b32 s72, 0, s72
    s_cmp_lg_u64 vcc, 0
    s_cbranch_scc0 L_kgo0
    buffer_load_dwordx4 v[76:79], v225, s[48:51], s22 offen sc1
    buffer_load_dwordx4 v[80:83], v225, s[48:51], s22 offen offset:1024 sc1
    buffer_load_dwordx4 v[84:87], v225, s[48:51], s22 offen offset:2048 sc1
    buffer_load_dwordx4 v[88:91], v225, s[48:51], s22 offen offset:3072 sc1
    s_waitcnt vmcnt(0)
    s_branch L_kchk0
L_kre1:
    s_sub_u32 s72, s72, 1
    s_cselect_b64 vcc, 0, vcc
    s_cselect_b32 s72, 0, s72
    s_cmp_lg_u64 vcc, 0
    s_cbranch_scc0 L_kgo1
    buffer_load_dwordx4 v[92:95], v225, s[48:51], s21 offen sc1
    buffer_load_dwordx4 v[96:99], v225, s[48:51], s21 offen offset:1024 sc1
    buffer_load_dwordx4 v[100:103], v225, s[48:51], s21 offen offset:2048 sc1
    buffer_load_dwordx4 v[104:107], v225, s[48:51], s21 offen offset:3072 sc1
    s_waitcnt vmcnt(0)
    s_branch L_kchk1
L_kre2:
    s_sub_u32 s72, s72, 1
    s_cselect_b64 vcc, 0, vcc
    s_cselect_b32 s72, 0, s72
    s_cmp_lg_u64 vcc, 0
    s_cbranch_scc0 L_kgo2
    buffer_load_dwordx4 v[108:111], v225, s[48:51], s20 offen sc1
    buffer_load_dwordx4 v[112:115], v225, s[48:51], s20 offen offset:1024 sc1
    buffer_load_dwordx4 v[116:119], v225, s[48:51], s20 offen offset:2048 sc1
    buffer_load_dwordx4 v[120:123], v225, s[48:51], s20 offen offset:3072 sc1
    s_waitcnt vmcnt(0)
    s_branch L_kchk2
L_kre3:
    s_sub_u32 s72, s72, 1
    s_cselect_b64 vcc, 0, vcc
    s_cselect_b32 s72, 0, s72
    s_cmp_lg_u64 vcc, 0
    s_cbranch_scc0 L_kgo3
    buffer_load_dwordx4 v[124:127], v225, s[48:51], s19 offen sc1
    buffer_load_dwordx4 v[128:131], v225, s[48:51], s19 offen offset:1024 sc1
    buffer_load_dwordx4 v[132:135], v225, s[48:51], s19 offen offset:2048 sc1
    buffer_load_dwordx4 v[136:139], v225, s[48:51], s19 offen offset:3072 sc1
    s_waitcnt vmcnt(0)
    s_branch L_kchk3
L_hpolla:
    buffer_load_dword v253, v229, s[48:51], s29 offen sc1
    s_waitcnt vmcnt(0)
L_hchka:
    v_cmp_ne_u32 vcc, s85, v253
    s_sub_u32 s72, s72, 1
    s_cselect_b64 vcc, 0, vcc
    s_cselect_b32 s72, 0, s72
    s_cmp_lg_u64 vcc, 0
    s_cbranch_scc1 L_hpolla
    s_xor_b32 s80, s31, 0
    buffer_load_dwordx4 a[128:131], v225, s[48:51], s80 offen sc1
    buffer_load_dwordx4 a[132:135], v225, s[48:51], s80 offen offset:1024 sc1
    buffer_load_dwordx4 a[136:139], v225, s[48:51], s80 offen offset:2048 sc1
    buffer_load_dwordx4 a[140:143], v225, s[48:51], s80 offen offset:3072 sc1
    s_xor_b32 s80, s31, 4096
    buffer_load_dwordx4 a[144:147], v225, s[48:51], s80 offen sc1
    buffer_load_dwordx4 a[148:151], v225, s[48:51], s80 offen offset:1024 sc1
    buffer_load_dwordx4 a[152:155], v225, s[48:51], s80 offen offset:2048 sc1
    buffer_load_dwordx4 a[156:159], v225, s[48:51], s80 offen offset:3072 sc1
    s_xor_b32 s80, s31, 8192
    buffer_load_dwordx4 a[160:163], v225, s[48:51], s80 offen sc1
    buffer_load_dwordx4 a[164:167], v225, s[48:51], s80 offen offset:1024 sc1
    s_waitcnt vmcnt(8) lgkmcnt(4)
    v_mfma_f32_16x16x32_bf16 v[36:39], v[68:71], a[128:131], v[8:11]
    buffer_load_dwordx4 a[168:171], v225, s[48:51], s80 offen offset:2048 sc1
    v_mfma_f32_16x16x32_bf16 v[44:47], v[68:71], a[132:135], v[16:19]
    ds_read_b128 v[92:95], v210 offset:0
    v_mfma_f32_16x16x32_bf16 v[40:43], v[72:75], a[128:131], v[12:15]
    v_mfma_f32_16x16x32_bf16 v[48:51], v[72:75], a[132:135], v[20:23]
    ds_read_b128 v[96:99], v210 offset:2048
    s_waitcnt lgkmcnt(4)
    v_mfma_f32_16x16x32_bf16 v[52:55], v[76:79], a[128:131], 0
    buffer_load_dwordx4 a[172:175], v225, s[48:51], s80 offen offset:3072 sc1
    v_mfma_f32_16x16x32_bf16 v[60:63], v[76:79], a[132:135], 0
    ds_read_b128 v[68:71], v213 offset:8192
    v_mfma_f32_16x16x32_bf16 v[56:59], v[80:83], a[128:131], 0
    v_mfma_f32_16x16x32_bf16 v[64:67], v[80:83], a[132:135], 0
    ds_read_b128 v[72:75], v213 offset:10240
    s_waitcnt vmcnt(8) lgkmcnt(4)
    v_mfma_f32_16x16x32_bf16 v[36:39], v[84:87], a[136:139], v[36:39]
    s_xor_b32 s80, s31, 12288
    buffer_load_dwordx4 a[176:179], v225, s[48:51], s80 offen sc1
    v_mfma_f32_16x16x32_bf16 v[44:47], v[84:87], a[140:143], v[44:47]
    ds_read_b128 v[76:79], v211 offset:8192
    v_mfma_f32_16x16x32_bf16 v[40:43], v[88:91], a[136:139], v[40:43]
    v_mfma_f32_16x16x32_bf16 v[48:51], v[88:91], a[140:143], v[48:51]
    ds_read_b128 v[80:83], v211 offset:10240
    s_waitcnt lgkmcnt(4)
    v_mfma_f32_16x16x32_bf16 v[52:55], v[92:95], a[136:139], v[52:55]
    buffer_load_dwordx4 a[180:183], v225, s[48:51], s80 offen offset:1024 sc1
    v_mfma_f32_16x16x32_bf16 v[60:63], v[92:95], a[140:143], v[60:63]
    ds_read_b128 v[84:87], v212 offset:8192
    v_mfma_f32_16x16x32_bf16 v[56:59], v[96:99], a[136:139], v[56:59]
    v_mfma_f32_16x16x32_bf16 v[64:67], v[96:99], a[140:143], v[64:67]
    ds_read_b128 v[88:91], v212 offset:10240
    s_waitcnt vmcnt(8) lgkmcnt(4)
    v_mfma_f32_16x16x32_bf16 v[36:39], v[68:71], a[144:147], v[36:39]
    buffer_load_dwordx4 a[184:187], v225, s[48:51], s80 offen offset:2048 sc1
    v_mfma_f32_16x16x32_bf16 v[44:47], v[68:71], a[148:151], v[44:47]
    ds_read_b128 v[92:95], v210 offset:8192
    v_mfma_f32_16x16x32_bf16 v[40:43], v[72:75], a[144:147], v[40:43]
    v_mfma_f32_16x16x32_bf16 v[48:51], v[72:75], a[148:151], v[48:51]
    ds_read_b128 v[96:99], v210 offset:10240
    s_waitcnt lgkmcnt(4)
    v_mfma_f32_16x16x32_bf16 v[52:55], v[76:79], a[144:147], v[52:55]
    buffer_load_dwordx4 a[188:191], v225, s[48:51], s80 offen offset:3072 sc1
    v_mfma_f32_16x16x32_bf16 v[60:63], v[76:79], a[148:151], v[60:63]
    ds_read_b128 v[68:71], v213 offset:16384
    v_mfma_f32_16x16x32_bf16 v[56:59], v[80:83], a[144:147], v[56:59]
    v_mfma_f32_16x16x32_bf16 v[64:67], v[80:83], a[148:151], v[64:67]
    ds_read_b128 v[72:75], v213 offset:18432
    s_waitcnt vmcnt(8) lgkmcnt(4)
    v_mfma_f32_16x16x32_bf16 v[36:39], v[84:87], a[152:155], v[36:39]
    s_xor_b32 s80, s31, 16384
    buffer_load_dwordx4 a[192:195], v225, s[48:51], s80 offen sc1
    v_mfma_f32_16x16x32_bf16 v[44:47], v[84:87], a[156:159], v[44:47]
    ds_read_b128 v[76:79], v211 offset:16384
    v_mfma_f32_16x16x32_bf16 v[40:43], v[88:91], a[152:155], v[40:43]
    v_mfma_f32_16x16x32_bf16 v[48:51], v[88:91], a[156:159], v[48:51]
    ds_read_b128 v[80:83], v211 offset:18432
    s_waitcnt lgkmcnt(4)
    v_mfma_f32_16x16x32_bf16 v[52:55], v[92:95], a[152:155], v[52:55]
    buffer_load_dwordx4 a[196:199], v225, s[48:51], s80 offen offset:1024 sc1
    v_mfma_f32_16x16x32_bf16 v[60:63], v[92:95], a[156:159], v[60:63]
    ds_read_b128 v[84:87], v212 offset:16384
    v_mfma_f32_16x16x32_bf16 v[56:59], v[96:99], a[152:155], v[56:59]
    v_mfma_f32_16x16x32_bf16 v[64:67], v[96:99], a[156:159], v[64:67]
    ds_read_b128 v[88:91], v212 offset:18432
    s_waitcnt vmcnt(8) lgkmcnt(4)
    v_mfma_f32_16x16x32_bf16 v[36:39], v[68:71], a[160:163], v[36:39]
    buffer_load_dwordx4 a[200:203], v225, s[48:51], s80 offen offset:2048 sc1
    v_mfma_f32_16x16x32_bf16 v[44:47], v[68:71], a[164:167], v[44:47]
    ds_read_b128 v[92:95], v210 offset:16384
    v_mfma_f32_16x16x32_bf16 v[40:43], v[72:75], a[160:163], v[40:43]
    v_mfma_f32_16x16x32_bf16 v[48:51], v[72:75], a[164:167], v[48:51]
    ds_read_b128 v[96:99], v210 offset:18432
    s_waitcnt lgkmcnt(4)
    v_mfma_f32_16x16x32_bf16 v[52:55], v[76:79], a[160:163], v[52:55]
    buffer_load_dwordx4 a[204:207], v225, s[48:51], s80 offen offset:3072 sc1
    v_mfma_f32_16x16x32_bf16 v[60:63], v[76:79], a[164:167], v[60:63]
    ds_read_b128 v[68:71], v213 offset:24576
    v_mfma_f32_16x16x32_bf16 v[56:59], v[80:83], a[160:163], v[56:59]
    v_mfma_f32_16x16x32_bf16 v[64:67], v[80:83], a[164:167], v[64:67]
    ds_read_b128 v[72:75], v213 offset:26624
    s_waitcnt vmcnt(8) lgkmcnt(4)
    v_mfma_f32_16x16x32_bf16 v[36:39], v[84:87], a[168:171], v[36:39]
    s_xor_b32 s80, s31, 20480
    buffer_load_dwordx4 a[208:211], v225, s[48:51], s80 offen sc1
    v_mfma_f32_16x16x32_bf16 v[44:47], v[84:87], a[172:175], v[44:47]
    ds_read_b128 v[76:79], v211 offset:24576
    v_mfma_f32_16x16x32_bf16 v[40:43], v[88:91], a[168:171], v[40:43]
    v_mfma_f32_16x16x32_bf16 v[48:51], v[88:91], a[172:175], v[48:51]
    ds_read_b128 v[80:83], v211 offset:26624
    s_waitcnt lgkmcnt(4)
    v_mfma_f32_16x16x32_bf16 v[52:55], v[92:95], a[168:171], v[52:55]
    buffer_load_dwordx4 a[212:215], v225, s[48:51], s80 offen offset:1024 sc1
    v_mfma_f32_16x16x32_bf16 v[60:63], v[92:95], a[172:175], v[60:63]
    ds_read_b128 v[84:87], v212 offset:24576
    v_mfma_f32_16x16x32_bf16 v[56:59], v[96:99], a[168:171], v[56:59]
    v_mfma_f32_16x16x32_bf16 v[64:67], v[96:99], a[172:175], v[64:67]
    ds_read_b128 v[88:91], v212 offset:26624
L_p2:
L_pg4144:
    s_cbranch_execz L_backs
    buffer_load_dword v255, v229, s[48:51], s28 offen sc1
    s_waitcnt vmcnt(9) lgkmcnt(4)
    v_mfma_f32_16x16x32_bf16 v[36:39], v[68:71], a[176:179], v[36:39]
    buffer_load_dwordx4 a[216:219], v225, s[48:51], s80 offen offset:2048 sc1
    v_mfma_f32_16x16x32_bf16 v[44:47], v[68:71], a[180:183], v[44:47]
    ds_read_b128 v[92:95], v210 offset:24576
    v_mfma_f32_16x16x32_bf16 v[40:43], v[72:75], a[176:179], v[40:43]
    v_mfma_f32_16x16x32_bf16 v[48:51], v[72:75], a[180:183], v[48:51]
    ds_read_b128 v[96:99], v210 offset:26624
    s_waitcnt lgkmcnt(4)
    v_mfma_f32_16x16x32_bf16 v[52:55], v[76:79], a[176:179], v[52:55]
    buffer_load_dwordx4 a[220:223], v225, s[48:51], s80 offen offset:3072 sc1
    v_mfma_f32_16x16x32_bf16 v[60:63], v[76:79], a[180:183], v[60:63]
    s_barrier
    v_xor_b32 v213, s27, v213
    ds_read_b128 v[68:71], v213 offset:0
    v_mfma_f32_16x16x32_bf16 v[56:59], v[80:83], a[176:179], v[56:59]
    v_mfma_f32_16x16x32_bf16 v[64:67], v[80:83], a[180:183], v[64:67]
    ds_read_b128 v[72:75], v213 offset:2048
    s_waitcnt vmcnt(9) lgkmcnt(4)
    v_mfma_f32_16x16x32_bf16 v[36:39], v[84:87], a[184:187], v[36:39]
    s_xor_b32 s80, s31, 24576
    buffer_load_dwordx4 a[224:227], v225, s[48:51], s80 offen sc1
    v_mfma_f32_16x16x32_bf16 v[44:47], v[84:87], a[188:191], v[44:47]
    v_xor_b32 v211, s27, v211
    ds_read_b128 v[76:79], v211 offset:0
    v_mfma_f32_16x16x32_bf16 v[40:43], v[88:91], a[184:187], v[40:43]
    v_mfma_f32_16x16x32_bf16 v[48:51], v[88:91], a[188:191], v[48:51]
    ds_read_b128 v[80:83], v211 offset:2048
    s_waitcnt lgkmcnt(4)
    v_mfma_f32_16x16x32_bf16 v[52:55], v[92:95], a[184:187], v[52:55]
    buffer_load_dwordx4 a[228:231], v225, s[48:51], s80 offen offset:1024 sc1
    v_mfma_f32_16x16x32_bf16 v[60:63], v[92:95], a[188:191], v[60:63]
    v_xor_b32 v212, s27, v212
    ds_read_b128 v[84:87], v212 offset:0
    v_mfma_f32_16x16x32_bf16 v[56:59], v[96:99], a[184:187], v[56:59]
    v_mfma_f32_16x16x32_bf16 v[64:67], v[96:99], a[188:191], v[64:67]
    ds_read_b128 v[88:91], v212 offset:2048
    s_waitcnt vmcnt(9) lgkmcnt(4)
    v_mfma_f32_16x16x32_bf16 v[36:39], v[68:71], a[192:195], v[36:39]
    buffer_load_dwordx4 a[232:235], v225, s[48:51], s80 offen offset:2048 sc1
    v_mfma_f32_16x16x32_bf16 v[44:47], v[68:71], a[196:199], v[44:47]
    v_xor_b32 v210, s27, v210
    ds_read_b128 v[92:95], v210 offset:0
    v_mfma_f32_16x16x32_bf16 v[40:43], v[72:75], a[192:195], v[40:43]
    v_mfma_f32_16x16x32_bf16 v[48:51], v[72:75], a[196:199], v[48:51]
    ds_read_b128 v[96:99], v210 offset:2048
    s_waitcnt lgkmcnt(4)
    v_mfma_f32_16x16x32_bf16 v[52:55], v[76:79], a[192:195], v[52:55]
    buffer_load_dwordx4 a[236:239], v225, s[48:51], s80 offen offset:3072 sc1
    v_mfma_f32_16x16x32_bf16 v[60:63], v[76:79], a[196:199], v[60:63]
    ds_read_b128 v[68:71], v213 offset:8192
    v_mfma_f32_16x16x32_bf16 v[56:59], v[80:83], a[192:195], v[56:59]
    v_mfma_f32_16x16x32_bf16 v[64:67], v[80:83], a[196:199], v[64:67]
    ds_read_b128 v[72:75], v213 offset:10240
    s_waitcnt vmcnt(9) lgkmcnt(4)
    v_mfma_f32_16x16x32_bf16 v[36:39], v[84:87], a[200:203], v[36:39]
    s_xor_b32 s80, s31, 28672
    buffer_load_dwordx4 a[240:243], v225, s[48:51], s80 offen sc1
    v_mfma_f32_16x16x32_bf16 v[44:47], v[84:87], a[204:207], v[44:47]
    ds_read_b128 v[76:79], v211 offset:8192
    v_mfma_f32_16x16x32_bf16 v[40:43], v[88:91], a[200:203], v[40:43]
    v_mfma_f32_16x16x32_bf16 v[48:51], v[88:91], a[204:207], v[48:51]
    ds_read_b128 v[80:83], v211 offset:10240
    s_waitcnt lgkmcnt(4)
    v_mfma_f32_16x16x32_bf16 v[52:55], v[92:95], a[200:203], v[52:55]
L_pg4212:
    s_cbranch_execz L_backx
    buffer_load_dwordx4 a[244:247], v225, s[48:51], s80 offen offset:1024 sc1
    v_mfma_f32_16x16x32_bf16 v[60:63], v[92:95], a[204:207], v[60:63]
    ds_read_b128 v[84:87], v212 offset:8192
    v_mfma_f32_16x16x32_bf16 v[56:59], v[96:99], a[200:203], v[56:59]
    v_mfma_f32_16x16x32_bf16 v[64:67], v[96:99], a[204:207], v[64:67]
    ds_read_b128 v[88:91], v212 offset:10240
    s_waitcnt vmcnt(9) lgkmcnt(4)
    v_mfma_f32_16x16x32_bf16 v[36:39], v[68:71], a[208:211], v[36:39]
    buffer_load_dwordx4 a[248:251], v225, s[48:51], s80 offen offset:2048 sc1
    v_mfma_f32_16x16x32_bf16 v[44:47], v[68:71], a[212:215], v[44:47]
    ds_read_b128 v[92:95], v210 offset:8192
    v_mfma_f32_16x16x32_bf16 v[40:43], v[72:75], a[208:211], v[40:43]
    v_mfma_f32_16x16x32_bf16 v[48:51], v[72:75], a[212:215], v[48:51]
    ds_read_b128 v[96:99], v210 offset:10240
    s_waitcnt lgkmcnt(4)
    v_mfma_f32_16x16x32_bf16 v[52:55], v[76:79], a[208:211], v[52:55]
    buffer_load_dwordx4 a[252:255], v225, s[48:51], s80 offen offset:3072 sc1
    v_mfma_f32_16x16x32_bf16 v[60:63], v[76:79], a[212:215], v[60:63]
    ds_read_b128 v[68:71], v213 offset:16384
    v_mfma_f32_16x16x32_bf16 v[56:59], v[80:83], a[208:211], v[56:59]
    v_mfma_f32_16x16x32_bf16 v[64:67], v[80:83], a[212:215], v[64:67]
    ds_read_b128 v[72:75], v213 offset:18432
    s_waitcnt vmcnt(10)
    v_cmp_ne_u32 vcc, s85, v255
    s_cmp_lg_u64 vcc, 0
    s_cbranch_scc1 L_slow
    s_waitcnt vmcnt(8) lgkmcnt(4)
    v_mfma_f32_16x16x32_bf16 v[36:39], v[84:87], a[216:219], v[36:39]
    s_xor_b32 s79, s30, 0
    buffer_load_dwordx4 v[100:103], v225, s[48:51], s79 offen sc1
    v_mfma_f32_16x16x32_bf16 v[44:47], v[84:87], a[220:223], v[44:47]
    ds_read_b128 v[76:79], v211 offset:16384
    v_mfma_f32_16x16x32_bf16 v[40:43], v[88:91], a[216:219], v[40:43]
    v_mfma_f32_16x16x32_bf16 v[48:51], v[88:91], a[220:223], v[48:51]
    ds_read_b128 v[80:83], v211 offset:18432
    s_waitcnt lgkmcnt(4)
    v_mfma_f32_16x16x32_bf16 v[52:55], v[92:95], a[216:219], v[52:55]
    buffer_load_dwordx4 v[104:107], v225, s[48:51], s79 offen offset:1024 sc1
    v_mfma_f32_16x16x32_bf16 v[60:63], v[92:95], a[220:223], v[60:63]
    ds_read_b128 v[84:87], v212 offset:16384
    v_mfma_f32_16x16x32_bf16 v[56:59], v[96:99], a[216:219], v[56:59]
    v_mfma_f32_16x16x32_bf16 v[64:67], v[96:99], a[220:223], v[64:67]
    ds_read_b128 v[88:91], v212 offset:18432
    s_waitcnt vmcnt(8) lgkmcnt(4)
    v_mfma_f32_16x16x32_bf16 v[36:39], v[68:71], a[224:227], v[36:39]
    buffer_load_dwordx4 v[108:111], v225, s[48:51], s79 offen offset:2048 sc1
    v_mfma_f32_16x16x32_bf16 v[44:47], v[68:71], a[228:231], v[44:47]
    ds_read_b128 v[92:95], v210 offset:16384
    v_mfma_f32_16x16x32_bf16 v[40:43], v[72:75], a[224:227], v[40:43]
    v_mfma_f32_16x16x32_bf16 v[48:51], v[72:75], a[228:231], v[48:51]
    ds_read_b128 v[96:99], v210 offset:18432
    s_waitcnt lgkmcnt(4)
    v_mfma_f32_16x16x32_bf16 v[52:55], v[76:79], a[224:227], v[52:55]
    buffer_load_dwordx4 v[112:115], v225, s[48:51], s79 offen offset:3072 sc1
    v_mfma_f32_16x16x32_bf16 v[60:63], v[76:79], a[228:231], v[60:63]
    ds_read_b128 v[68:71], v213 offset:24576
    v_mfma_f32_16x16x32_bf16 v[56:59], v[80:83], a[224:227], v[56:59]
    v_mfma_f32_16x16x32_bf16 v[64:67], v[80:83], a[228:231], v[64:67]
    ds_read_b128 v[72:75], v213 offset:26624
    s_waitcnt vmcnt(8) lgkmcnt(4)
    v_mfma_f32_16x16x32_bf16 v[36:39], v[84:87], a[232:235], v[36:39]
    s_xor_b32 s79, s30, 4096
    buffer_load_dwordx4 v[116:119], v225, s[48:51], s79 offen sc1
    v_mfma_f32_16x16x32_bf16 v[44:47], v[84:87], a[236:239], v[44:47]
    ds_read_b128 v[76:79], v211 offset:24576
    v_mfma_f32_16x16x32_bf16 v[40:43], v[88:91], a[232:235], v[40:43]
    v_mfma_f32_16x16x32_bf16 v[48:51], v[88:91], a[236:239], v[48:51]
    ds_read_b128 v[80:83], v211 offset:26624
    s_waitcnt lgkmcnt(4)
    v_mfma_f32_16x16x32_bf16 v[52:55], v[92:95], a[232:235], v[52:55]
    buffer_load_dwordx4 v[120:123], v225, s[48:51], s79 offen offset:1024 sc1
    v_mfma_f32_16x16x32_bf16 v[60:63], v[92:95], a[236:239], v[60:63]
    ds_read_b128 v[84:87], v212 offset:24576
    v_mfma_f32_16x16x32_bf16 v[56:59], v[96:99], a[232:235], v[56:59]
    v_mfma_f32_16x16x32_bf16 v[64:67], v[96:99], a[236:239], v[64:67]
    ds_read_b128 v[88:91], v212 offset:26624
    s_waitcnt vmcnt(8) lgkmcnt(4)
    v_mfma_f32_16x16x32_bf16 v[36:39], v[68:71], a[240:243], v[36:39]
    buffer_load_dwordx4 v[124:127], v225, s[48:51], s79 offen offset:2048 sc1
    v_mfma_f32_16x16x32_bf16 v[44:47], v[68:71], a[244:247], v[44:47]
    ds_read_b128 v[92:95], v210 offset:24576
    v_mfma_f32_16x16x32_bf16 v[40:43], v[72:75], a[240:243], v[40:43]
    v_mfma_f32_16x16x32_bf16 v[48:51], v[72:75], a[244:247], v[48:51]
    ds_read_b128 v[96:99], v210 offset:26624
    s_waitcnt lgkmcnt(4)
    v_mfma_f32_16x16x32_bf16 v[52:55], v[76:79], a[240:243], v[52:55]
    buffer_load_dwordx4 v[128:131], v225, s[48:51], s79 offen offset:3072 sc1
    v_mfma_f32_16x16x32_bf16 v[60:63], v[76:79], a[244:247], v[60:63]
    v_mfma_f32_16x16x32_bf16 v[56:59], v[80:83], a[240:243], v[56:59]
    v_mfma_f32_16x16x32_bf16 v[64:67], v[80:83], a[244:247], v[64:67]
    s_waitcnt vmcnt(8) lgkmcnt(2)
    v_mfma_f32_16x16x32_bf16 v[36:39], v[84:87], a[248:251], v[36:39]
    s_xor_b32 s79, s30, 8192
    buffer_load_dwordx4 v[132:135], v225, s[48:51], s79 offen sc1
    v_mfma_f32_16x16x32_bf16 v[44:47], v[84:87], a[252:255], v[44:47]
    v_mfma_f32_16x16x32_bf16 v[40:43], v[88:91], a[248:251], v[40:43]
    v_mfma_f32_16x16x32_bf16 v[48:51], v[88:91], a[252:255], v[48:51]
    s_waitcnt lgkmcnt(0)
    v_mfma_f32_16x16x32_bf16 v[52:55], v[92:95], a[248:251], v[52:55]
    buffer_load_dwordx4 v[136:139], v225, s[48:51], s79 offen offset:1024 sc1
    v_mfma_f32_16x16x32_bf16 v[60:63], v[92:95], a[252:255], v[60:63]
    v_mfma_f32_16x16x32_bf16 v[56:59], v[96:99], a[248:251], v[56:59]
    v_mfma_f32_16x16x32_bf16 v[64:67], v[96:99], a[252:255], v[64:67]
L_join:
    s_waitcnt vmcnt(8)
    v_mfma_f32_16x16x32_bf16 v[52:55], a[8:11], v[100:103], v[52:55]
    buffer_load_dwordx4 v[140:143], v225, s[48:51], s79 offen offset:2048 sc1
    v_mfma_f32_16x16x32_bf16 v[60:63], a[8:11], v[104:107], v[60:63]
    ds_read_b64_tr_b16 a[72:73], v215 offset:0
    v_mfma_f32_16x16x32_bf16 v[56:59], a[12:15], v[100:103], v[56:59]
    ds_read_b64_tr_b16 a[74:75], v215 offset:2048
    v_mfma_f32_16x16x32_bf16 v[64:67], a[12:15], v[104:107], v[64:67]
    ds_read_b64_tr_b16 a[76:77], v214 offset:0
    v_mfma_f32_16x16x32_bf16 v[36:39], a[0:3], v[100:103], v[36:39]
    buffer_load_dwordx4 v[144:147], v225, s[48:51], s79 offen offset:3072 sc1
    v_mfma_f32_16x16x32_bf16 v[44:47], a[0:3], v[104:107], v[44:47]
    ds_read_b64_tr_b16 a[78:79], v214 offset:2048
    v_mfma_f32_16x16x32_bf16 v[40:43], a[4:7], v[100:103], v[40:43]
    ds_read_b64_tr_b16 a[88:89], v215 offset:4096
    v_mfma_f32_16x16x32_bf16 v[48:51], a[4:7], v[104:107], v[48:51]
    ds_read_b64_tr_b16 a[90:91], v215 offset:6144
    s_waitcnt vmcnt(8)
    v_mfma_f32_16x16x32_bf16 v[52:55], a[24:27], v[108:111], v[52:55]
    s_xor_b32 s79, s30, 12288
    buffer_load_dwordx4 v[148:151], v225, s[48:51], s79 offen sc1
    v_mfma_f32_16x16x32_bf16 v[60:63], a[24:27], v[112:115], v[60:63]
    ds_read_b64_tr_b16 a[92:93], v214 offset:4096
    v_mfma_f32_16x16x32_bf16 v[56:59], a[28:31], v[108:111], v[56:59]
    ds_read_b64_tr_b16 a[94:95], v214 offset:6144
    v_mfma_f32_16x16x32_bf16 v[64:67], a[28:31], v[112:115], v[64:67]
    ds_read_b64_tr_b16 a[104:105], v215 offset:8192
    v_mfma_f32_16x16x32_bf16 v[36:39], a[16:19], v[108:111], v[36:39]
    buffer_load_dwordx4 v[152:155], v225, s[48:51], s79 offen offset:1024 sc1
    v_mfma_f32_16x16x32_bf16 v[44:47], a[16:19], v[112:115], v[44:47]
    ds_read_b64_tr_b16 a[106:107], v215 offset:10240
    v_mfma_f32_16x16x32_bf16 v[40:43], a[20:23], v[108:111], v[40:43]
    ds_read_b64_tr_b16 a[108:109], v214 offset:8192
    v_mfma_f32_16x16x32_bf16 v[48:51], a[20:23], v[112:115], v[48:51]
    ds_read_b64_tr_b16 a[110:111], v214 offset:10240
    s_waitcnt vmcnt(8)
    v_mfma_f32_16x16x32_bf16 v[52:55], a[40:43], v[116:119], v[52:55]
    buffer_load_dwordx4 v[156:159], v225, s[48:51], s79 offen offset:2048 sc1
    v_mfma_f32_16x16x32_bf16 v[60:63], a[40:43], v[120:123], v[60:63]
    ds_read_b64_tr_b16 a[120:121], v215 offset:12288
    v_mfma_f32_16x16x32_bf16 v[56:59], a[44:47], v[116:119], v[56:59]
    ds_read_b64_tr_b16 a[122:123], v215 offset:14336
    v_mfma_f32_16x16x32_bf16 v[64:67], a[44:47], v[120:123], v[64:67]
    ds_read_b64_tr_b16 a[124:125], v214 offset:12288
    v_mfma_f32_16x16x32_bf16 v[36:39], a[32:35], v[116:119], v[36:39]
    buffer_load_dwordx4 v[160:163], v225, s[48:51], s79 offen offset:3072 sc1
    v_mfma_f32_16x16x32_bf16 v[44:47], a[32:35], v[120:123], v[44:47]
    ds_read_b64_tr_b16 a[126:127], v214 offset:14336
    v_mfma_f32_16x16x32_bf16 v[40:43], a[36:39], v[116:119], v[40:43]
    ds_read_b64_tr_b16 a[64:65], v217 offset:0
    v_mfma_f32_16x16x32_bf16 v[48:51], a[36:39], v[120:123], v[48:51]
    ds_read_b64_tr_b16 a[66:67], v217 offset:2048
    s_waitcnt vmcnt(8)
    v_mfma_f32_16x16x32_bf16 v[52:55], a[56:59], v[124:127], v[52:55]
    s_movk_i32 s78, 4096
    s_mov_b32 s77, 0x10000
    v_mfma_f32_16x16x32_bf16 v[60:63], a[56:59], v[128:131], v[60:63]
    ds_read_b64_tr_b16 a[68:69], v216 offset:0
    v_mfma_f32_16x16x32_bf16 v[56:59], a[60:63], v[124:127], v[56:59]
    ds_read_b64_tr_b16 a[70:71], v216 offset:2048
    v_mfma_f32_16x16x32_bf16 v[64:67], a[60:63], v[128:131], v[64:67]
    ds_read_b64_tr_b16 a[80:81], v217 offset:4096
    v_mfma_f32_16x16x32_bf16 v[36:39], a[48:51], v[124:127], v[36:39]
    s_mov_b32 s80, 0x11000
    v_xor_b32 v68, 128, v228
    v_mfma_f32_16x16x32_bf16 v[44:47], a[48:51], v[128:131], v[44:47]
    ds_read_b64_tr_b16 a[82:83], v217 offset:6144
    v_mfma_f32_16x16x32_bf16 v[40:43], a[52:55], v[124:127], v[40:43]
    ds_read_b64_tr_b16 a[84:85], v216 offset:4096
    v_mfma_f32_16x16x32_bf16 v[48:51], a[52:55], v[128:131], v[48:51]
    ds_read_b64_tr_b16 a[86:87], v216 offset:6144
    s_waitcnt vmcnt(6) lgkmcnt(14)
    v_mfma_f32_16x16x32_bf16 v[52:55], a[72:75], v[132:135], v[52:55]
    v_bfe_u32 v69, v0, 0, 3
    v_lshlrev_b32 v69, 5, v69
    v_mfma_f32_16x16x32_bf16 v[60:63], a[72:75], v[136:139], v[60:63]
    ds_read_b64_tr_b16 a[96:97], v217 offset:8192
    v_mfma_f32_16x16x32_bf16 v[56:59], a[76:79], v[132:135], v[56:59]
    ds_read_b64_tr_b16 a[98:99], v217 offset:10240
    v_mfma_f32_16x16x32_bf16 v[64:67], a[76:79], v[136:139], v[64:67]
    ds_read_b64_tr_b16 a[100:101], v216 offset:8192
    s_waitcnt vmcnt(4) lgkmcnt(14)
    v_mfma_f32_16x16x32_bf16 v[52:55], a[88:91], v[140:143], v[52:55]
    v_bfe_u32 v70, v0, 0, 2
    v_lshl_or_b32 v69, v70, 8, v69
    v_mfma_f32_16x16x32_bf16 v[60:63], a[88:91], v[144:147], v[60:63]
    ds_read_b64_tr_b16 a[102:103], v216 offset:10240
    v_mfma_f32_16x16x32_bf16 v[56:59], a[92:95], v[140:143], v[56:59]
    ds_read_b64_tr_b16 a[112:113], v217 offset:12288
    v_mfma_f32_16x16x32_bf16 v[64:67], a[92:95], v[144:147], v[64:67]
    ds_read_b64_tr_b16 a[114:115], v217 offset:14336
    s_waitcnt vmcnt(2) lgkmcnt(14)
    v_mfma_f32_16x16x32_bf16 v[52:55], a[104:107], v[148:151], v[52:55]
    v_bfe_u32 v70, v0, 2, 1
    v_lshl_or_b32 v69, v70, 10, v69
    v_mfma_f32_16x16x32_bf16 v[60:63], a[104:107], v[152:155], v[60:63]
    ds_read_b64_tr_b16 a[116:117], v216 offset:12288
    v_mfma_f32_16x16x32_bf16 v[56:59], a[108:111], v[148:151], v[56:59]
    ds_read_b64_tr_b16 a[118:119], v216 offset:14336
    v_bfe_u32 v70, v0, 3, 3
    v_lshlrev_b32 v70, 4, v70
    v_mfma_f32_16x16x32_bf16 v[64:67], a[108:111], v[152:155], v[64:67]
    v_xor_b32 v69, v69, v70
    v_and_b32 v70, 0xfffff000, v228
    s_waitcnt vmcnt(0) lgkmcnt(14)
    v_mfma_f32_16x16x32_bf16 v[52:55], a[120:123], v[156:159], v[52:55]
    v_add_u32 v71, v69, v70
    v_xor_b32 v72, 128, v71
    v_mfma_f32_16x16x32_bf16 v[60:63], a[120:123], v[160:163], v[60:63]
    v_xor_b32 v69, 8192, v71
    v_xor_b32 v70, 8192, v72
    v_mfma_f32_16x16x32_bf16 v[56:59], a[124:127], v[156:159], v[56:59]
    v_mfma_f32_16x16x32_bf16 v[64:67], a[124:127], v[160:163], v[64:67]
    s_waitcnt lgkmcnt(12)
    v_mfma_f32_16x16x32_bf16 v[36:39], a[64:67], v[132:135], v[36:39]
    v_mfma_f32_16x16x32_bf16 v[44:47], a[64:67], v[136:139], v[44:47]
    v_mfma_f32_16x16x32_bf16 v[40:43], a[68:71], v[132:135], v[40:43]
    v_mfma_f32_16x16x32_bf16 v[48:51], a[68:71], v[136:139], v[48:51]
    s_waitcnt lgkmcnt(0)
    v_mfma_f32_16x16x32_bf16 v[36:39], a[80:83], v[140:143], v[36:39]
    ds_write_b128 v228, v[52:55] offset:0
    v_mfma_f32_16x16x32_bf16 v[44:47], a[80:83], v[144:147], v[44:47]
    ds_write_b128 v228, v[60:63] offset:2048
    v_mfma_f32_16x16x32_bf16 v[40:43], a[84:87], v[140:143], v[40:43]
    ds_write_b128 v68, v[56:59] offset:1024
    v_mfma_f32_16x16x32_bf16 v[48:51], a[84:87], v[144:147], v[48:51]
    ds_write_b128 v68, v[64:67] offset:3072
    v_mfma_f32_16x16x32_bf16 v[36:39], a[96:99], v[148:151], v[36:39]
    v_mfma_f32_16x16x32_bf16 v[44:47], a[96:99], v[152:155], v[44:47]
    v_mfma_f32_16x16x32_bf16 v[40:43], a[100:103], v[148:151], v[40:43]
    v_mfma_f32_16x16x32_bf16 v[48:51], a[100:103], v[152:155], v[48:51]
    s_waitcnt lgkmcnt(0)
    s_barrier
    v_mfma_f32_16x16x32_bf16 v[36:39], a[112:115], v[156:159], v[36:39]
    ds_read_b128 v[100:103], v69 offset:0
    v_mfma_f32_16x16x32_bf16 v[40:43], a[116:119], v[156:159], v[40:43]
    ds_read_b128 v[104:107], v70 offset:0
    v_mfma_f32_16x16x32_bf16 v[44:47], a[112:115], v[160:163], v[44:47]
    ds_read_b128 v[108:111], v69 offset:2048
    v_mfma_f32_16x16x32_bf16 v[48:51], a[116:119], v[160:163], v[48:51]
    ds_read_b128 v[112:115], v70 offset:2048
    s_nop 0
    ds_write_b128 v228, v[36:39] offset:32768
    s_nop 0
    ds_write_b128 v68, v[40:43] offset:33792
    ds_read_b128 v[52:55], v71 offset:32768
    ds_read_b128 v[56:59], v72 offset:32768
    ds_write_b128 v228, v[44:47] offset:34816
    ds_write_b128 v68, v[48:51] offset:35840
    ds_read_b128 v[60:63], v71 offset:34816
    ds_read_b128 v[64:67], v72 offset:34816
    s_waitcnt lgkmcnt(5)
    v_pk_add_f32 v[52:53], v[52:53], v[100:101]
    v_pk_add_f32 v[54:55], v[54:55], v[102:103]
    buffer_store_dwordx4 v[52:55], v227, s[64:67], 0 offen sc1 nt
    s_waitcnt lgkmcnt(4)
    v_pk_add_f32 v[56:57], v[56:57], v[104:105]
    v_pk_add_f32 v[58:59], v[58:59], v[106:107]
    buffer_store_dwordx4 v[56:59], v227, s[64:67], s77 offen sc1 nt
    s_waitcnt lgkmcnt(1)
    v_pk_add_f32 v[60:61], v[60:61], v[108:109]
    v_pk_add_f32 v[62:63], v[62:63], v[110:111]
    buffer_store_dwordx4 v[60:63], v227, s[64:67], s78 offen sc1 nt
    s_waitcnt lgkmcnt(0)
    v_pk_add_f32 v[64:65], v[64:65], v[112:113]
    v_pk_add_f32 v[66:67], v[66:67], v[114:115]
    buffer_store_dwordx4 v[64:67], v227, s[64:67], s80 offen sc1 nt
    s_cmp_eq_u32 s2, 255
    s_cbranch_scc0 L_fin
    v_mov_b32 v255, s84
    v_mov_b32 v254, 0
    buffer_store_dword v255, v254, s[48:51], 0 offen sc1
L_fin:
    s_endpgm
L_slow:
    s_waitcnt vmcnt(8) lgkmcnt(4)
    v_mfma_f32_16x16x32_bf16 v[36:39], v[84:87], a[216:219], v[36:39]
    v_mfma_f32_16x16x32_bf16 v[44:47], v[84:87], a[220:223], v[44:47]
    ds_read_b128 v[76:79], v211 offset:16384
    v_mfma_f32_16x16x32_bf16 v[40:43], v[88:91], a[216:219], v[40:43]
    v_mfma_f32_16x16x32_bf16 v[48:51], v[88:91], a[220:223], v[48:51]
    ds_read_b128 v[80:83], v211 offset:18432
    s_waitcnt lgkmcnt(4)
    v_mfma_f32_16x16x32_bf16 v[52:55], v[92:95], a[216:219], v[52:55]
    v_mfma_f32_16x16x32_bf16 v[60:63], v[92:95], a[220:223], v[60:63]
    ds_read_b128 v[84:87], v212 offset:16384
    v_mfma_f32_16x16x32_bf16 v[56:59], v[96:99], a[216:219], v[56:59]
    v_mfma_f32_16x16x32_bf16 v[64:67], v[96:99], a[220:223], v[64:67]
    ds_read_b128 v[88:91], v212 offset:18432
    s_waitcnt vmcnt(6) lgkmcnt(4)
    v_mfma_f32_16x16x32_bf16 v[36:39], v[68:71], a[224:227], v[36:39]
    v_mfma_f32_16x16x32_bf16 v[44:47], v[68:71], a[228:231], v[44:47]
    ds_read_b128 v[92:95], v210 offset:16384
    v_mfma_f32_16x16x32_bf16 v[40:43], v[72:75], a[224:227], v[40:43]
    v_mfma_f32_16x16x32_bf16 v[48:51], v[72:75], a[228:231], v[48:51]
    ds_read_b128 v[96:99], v210 offset:18432
    s_waitcnt lgkmcnt(4)
    v_mfma_f32_16x16x32_bf16 v[52:55], v[76:79], a[224:227], v[52:55]
    v_mfma_f32_16x16x32_bf16 v[60:63], v[76:79], a[228:231], v[60:63]
    ds_read_b128 v[68:71], v213 offset:24576
    v_mfma_f32_16x16x32_bf16 v[56:59], v[80:83], a[224:227], v[56:59]
    v_mfma_f32_16x16x32_bf16 v[64:67], v[80:83], a[228:231], v[64:67]
    ds_read_b128 v[72:75], v213 offset:26624
    s_waitcnt vmcnt(4) lgkmcnt(4)
    v_mfma_f32_16x16x32_bf16 v[36:39], v[84:87], a[232:235], v[36:39]
    v_mfma_f32_16x16x32_bf16 v[44:47], v[84:87], a[236:239], v[44:47]
    ds_read_b128 v[76:79], v211 offset:24576
    v_mfma_f32_16x16x32_bf16 v[40:43], v[88:91], a[232:235], v[40:43]
    v_mfma_f32_16x16x32_bf16 v[48:51], v[88:91], a[236:239], v[48:51]
    ds_read_b128 v[80:83], v211 offset:26624
    s_waitcnt lgkmcnt(4)
    v_mfma_f32_16x16x32_bf16 v[52:55], v[92:95], a[232:235], v[52:55]
    v_mfma_f32_16x16x32_bf16 v[60:63], v[92:95], a[236:239], v[60:63]
    ds_read_b128 v[84:87], v212 offset:24576
    v_mfma_f32_16x16x32_bf16 v[56:59], v[96:99], a[232:235], v[56:59]
    v_mfma_f32_16x16x32_bf16 v[64:67], v[96:99], a[236:239], v[64:67]
    ds_read_b128 v[88:91], v212 offset:26624
    s_waitcnt vmcnt(2) lgkmcnt(4)
    v_mfma_f32_16x16x32_bf16 v[36:39], v[68:71], a[240:243], v[36:39]
    v_mfma_f32_16x16x32_bf16 v[44:47], v[68:71], a[244:247], v[44:47]
    ds_read_b128 v[92:95], v210 offset:24576
    v_mfma_f32_16x16x32_bf16 v[40:43], v[72:75], a[240:243], v[40:43]
    v_mfma_f32_16x16x32_bf16 v[48:51], v[72:75], a[244:247], v[48:51]
    ds_read_b128 v[96:99], v210 offset:26624
    s_waitcnt lgkmcnt(4)
    v_mfma_f32_16x16x32_bf16 v[52:55], v[76:79], a[240:243], v[52:55]
    v_mfma_f32_16x16x32_bf16 v[60:63], v[76:79], a[244:247], v[60:63]
    v_mfma_f32_16x16x32_bf16 v[56:59], v[80:83], a[240:243], v[56:59]
    v_mfma_f32_16x16x32_bf16 v[64:67], v[80:83], a[244:247], v[64:67]
    s_waitcnt vmcnt(0) lgkmcnt(2)
    v_mfma_f32_16x16x32_bf16 v[36:39], v[84:87], a[248:251], v[36:39]
    v_mfma_f32_16x16x32_bf16 v[44:47], v[84:87], a[252:255], v[44:47]
    v_mfma_f32_16x16x32_bf16 v[40:43], v[88:91], a[248:251], v[40:43]
    v_mfma_f32_16x16x32_bf16 v[48:51], v[88:91], a[252:255], v[48:51]
    s_waitcnt lgkmcnt(0)
    v_mfma_f32_16x16x32_bf16 v[52:55], v[92:95], a[248:251], v[52:55]
    v_mfma_f32_16x16x32_bf16 v[60:63], v[92:95], a[252:255], v[60:63]
    v_mfma_f32_16x16x32_bf16 v[56:59], v[96:99], a[248:251], v[56:59]
    v_mfma_f32_16x16x32_bf16 v[64:67], v[96:99], a[252:255], v[64:67]
L_opoll:
    buffer_load_dword v255, v229, s[48:51], s28 offen sc1
    s_waitcnt vmcnt(0)
    v_cmp_ne_u32 vcc, s85, v255
    s_sub_u32 s72, s72, 1
    s_cselect_b64 vcc, 0, vcc
    s_cselect_b32 s72, 0, s72
    s_cmp_lg_u64 vcc, 0
    s_cbranch_scc1 L_opoll
    s_xor_b32 s79, s30, 0
    buffer_load_dwordx4 v[100:103], v225, s[48:51], s79 offen sc1
    buffer_load_dwordx4 v[104:107], v225, s[48:51], s79 offen offset:1024 sc1
    buffer_load_dwordx4 v[108:111], v225, s[48:51], s79 offen offset:2048 sc1
    buffer_load_dwordx4 v[112:115], v225, s[48:51], s79 offen offset:3072 sc1
    s_xor_b32 s79, s30, 4096
    buffer_load_dwordx4 v[116:119], v225, s[48:51], s79 offen sc1
    buffer_load_dwordx4 v[120:123], v225, s[48:51], s79 offen offset:1024 sc1
    buffer_load_dwordx4 v[124:127], v225, s[48:51], s79 offen offset:2048 sc1
    buffer_load_dwordx4 v[128:131], v225, s[48:51], s79 offen offset:3072 sc1
    s_xor_b32 s79, s30, 8192
    buffer_load_dwordx4 v[132:135], v225, s[48:51], s79 offen sc1
    buffer_load_dwordx4 v[136:139], v225, s[48:51], s79 offen offset:1024 sc1
    s_branch L_join
L_end:
    s_endpgm
.section .rodata,"a"
.p2align 6
.amdhsa_kernel gated_mix__linear_attn_block__ssm_conv_s5__prompt_kernel
  .amdhsa_next_free_vgpr 512
  .amdhsa_next_free_sgpr 102
  .amdhsa_accum_offset 256
  .amdhsa_group_segment_fixed_size 0
  .amdhsa_kernarg_size 128
  .amdhsa_user_sgpr_count 2
  .amdhsa_user_sgpr_kernarg_segment_ptr 1
  .amdhsa_system_sgpr_workgroup_id_x 1
  .amdhsa_float_denorm_mode_32 3
.end_amdhsa_kernel
```
